```python
import torch

def _softmax(x, axis=-1):
    return torch.softmax(x, dim=axis)
def _gelu(x):
    return torch.nn.functional.gelu(x, approximate="tanh")
def _silu(x):
    return torch.nn.functional.silu(x)
def _sigmoid(x):
    return torch.sigmoid(x)
def _layernorm(x, axis=-1, eps=1e-5):
    m = x.mean(dim=axis, keepdim=True)
    v = x.var(dim=axis, keepdim=True, unbiased=False)
    return (x - m) / torch.sqrt(v + eps)
def _scatter_add(tgt, idx, src, axis=0):
    return tgt.clone().index_add_(axis, idx, src)
def _segment_sum(src, seg, n):
    out = torch.zeros((n,) + src.shape[1:], dtype=src.dtype)
    return out.index_add_(0, seg, src)
def _pad(x, pw):
    flat = tuple(v for pair in reversed(pw) for v in pair)
    return torch.nn.functional.pad(x, flat)

kernel_name = 'concat_heads__ssm_conv_s4d__grouped_kv_mqa__prompt'

def setup_inputs():

    _w = (lambda a: (lambda t: t.to(torch.bfloat16) if t.is_floating_point() else t)(torch.as_tensor(a)))
    def _A_setup():
        Bsz, L, D, N = 1, 2048, 448, 256
        return {
            "u": _w((lambda *s: torch.randn(*s, dtype=torch.bfloat16) * 0.05)(Bsz, L, D)),
            "log_A_real": _w((lambda *s: torch.randn(*s, dtype=torch.bfloat16) * 6.4)(D, N) * 0.5),
            "A_imag": _w((lambda *s: torch.randn(*s, dtype=torch.bfloat16) * 0.05)(D, N) * 3.14),
            "C_real": _w((lambda *s: torch.randn(*s, dtype=torch.bfloat16) * 0.4)(D, N) / N ** 0.5),
            "C_imag": _w((lambda *s: torch.randn(*s, dtype=torch.bfloat16) * 0.4)(D, N) / N ** 0.5),
            "log_dt": _w((lambda *s: torch.randn(*s, dtype=torch.bfloat16) * 0.05)(D) * 0.5 - 4.0),
            "D_skip": _w((lambda *s: torch.randn(*s, dtype=torch.bfloat16) * 0.05)(D)),
        }
    _A_in = _A_setup()

    def _B_setup():
        B, S, D, H = 1, 2048, 448, 16
        Dh = D // H
        return {
            "x": _w((lambda *s: torch.randn(*s, dtype=torch.bfloat16) * 0.05)(B, S, D)),
            "wq": _w((lambda *s: torch.randn(*s, dtype=torch.bfloat16) * 1.6)(D, H * Dh)),
            "wk": _w((lambda *s: torch.randn(*s, dtype=torch.bfloat16) * 1.6)(D, Dh)),
            "wv": _w((lambda *s: torch.randn(*s, dtype=torch.bfloat16) * 0.05)(D, Dh)),
            "wo": _w((lambda *s: torch.randn(*s, dtype=torch.bfloat16) * 0.05)(H * Dh, D)),
        }
    _B_in = _B_setup()

    return {
        "A_u": _A_in["u"],
        "A_log_A_real": _A_in["log_A_real"],
        "A_A_imag": _A_in["A_imag"],
        "A_C_real": _A_in["C_real"],
        "A_C_imag": _A_in["C_imag"],
        "A_log_dt": _A_in["log_dt"],
        "A_D_skip": _A_in["D_skip"],
        "B_x": _B_in["x"],
        "B_wq": _B_in["wq"],
        "B_wk": _B_in["wk"],
        "B_wv": _B_in["wv"],
        "B_wo": _B_in["wo"],
    }

def reference(A_u, A_log_A_real, A_A_imag, A_C_real, A_C_imag, A_log_dt, A_D_skip, B_x, B_wq, B_wk, B_wv, B_wo):
    def _A_ref(u, log_A_real, A_imag, C_real, C_imag, log_dt, D_skip):
        L = u.shape[1]
        dt = torch.exp(log_dt)
        A = -torch.exp(log_A_real) + 1j * A_imag
        C = (C_real + 1j * C_imag) * dt[:, None]
        pos = (lambda x, dt: x.to(dt))(torch.arange(L), log_dt.dtype)
        P = torch.exp((A * dt[:, None])[:, :, None] * pos[None, None, :])
        K = 2.0 * torch.einsum("dn,dnl->dl", C, P).real
        L2 = 2 * L
        u_t = (lambda x, *d: x.permute(*d))(u, 0, 2, 1)
        Kf = (lambda x, *a, **k: torch.fft.rfft(x.float(), *a, **k))(K, L2)
        Uf = (lambda x, *a, **k: torch.fft.rfft(x.float(), *a, **k))(u_t, L2)
        y = (lambda x, *a, **k: torch.fft.irfft(x, *a, **k).to(torch.bfloat16))(Uf * Kf[None, :, :], L2)[:, :, :L]
        y = (lambda x, *d: x.permute(*d))(y, 0, 2, 1)
        return y + u * D_skip[None, None, :]

    def _B_ref(x, wq, wk, wv, wo):
        B, S, D = x.shape
        H = 16
        Dh = D // H
        q = (lambda x, *d: x.permute(*d))((x @ wq).reshape(B, S, H, Dh), 0, 2, 1, 3)
        k = x @ wk
        v = x @ wv
        scores = torch.einsum("bhqd,bkd->bhqk", q, k) * (Dh ** -0.5)
        p = _softmax(scores, axis=-1)
        o = torch.einsum("bhqk,bkd->bhqd", p, v)
        return (lambda x, *d: x.permute(*d))(o, 0, 2, 1, 3).reshape(B, S, H * Dh) @ wo

    a = _A_ref(A_u, A_log_A_real, A_A_imag, A_C_real, A_C_imag, A_log_dt, A_D_skip)
    b = _B_ref(B_x, B_wq, B_wk, B_wv, B_wo)
    return torch.concatenate([a, b], axis=-1)
```

```asm
; @launch grid=(512,1,1) block=(256,1,1) lds=81920
.amdgcn_target "amdgcn-amd-amdhsa--gfx950"
.text
.globl concat_heads__ssm_conv_s4d__grouped_kv_mqa__prompt_kernel
.p2align 8
.type concat_heads__ssm_conv_s4d__grouped_kv_mqa__prompt_kernel,@function
concat_heads__ssm_conv_s4d__grouped_kv_mqa__prompt_kernel:
  s_cmp_ge_u32 s2, 512
  s_cbranch_scc1 L_end_concat_heads__ssm_conv_s4d__grouped_kv_mqa__prompt_kernel
  s_load_dwordx16 s[16:31], s[0:1], 0
  s_load_dwordx8 s[32:39], s[0:1], 64
  s_load_dwordx4 s[40:43], s[0:1], 96
  s_load_dwordx2 s[44:45], s[0:1], 112
  v_lshrrev_b32 v1, 6, v0
  v_and_b32 v0, 63, v0
  s_and_b32 s4, s2, 7
  s_bfe_u32 s5, s2, 0x50003
  v_readfirstlane_b32 s3, v1
  s_cmp_ge_u32 s2, 256
  s_cbranch_scc1 L_roleA_1
  s_setprio 3
  s_mul_i32 s8, s4, 28
  s_add_u32 s8, s8, s5
  s_lshr_b32 s73, s8, 5
  s_and_b32 s96, s8, 31
  s_lshl_b32 s8, s73, 6
  s_lshl_b32 s9, s96, 1
  s_add_u32 s74, s8, s9
  v_lshlrev_b32 v15, 4, v0
  s_lshl_b32 s14, s74, 1
  s_lshr_b32 s10, s3, 1
  s_add_u32 s74, s74, s10
  s_and_b32 s9, s3, 1
  s_lshl_b32 s8, s74, 9
  s_lshl_b32 s12, s9, 8
  s_add_u32 s8, s8, s12
  v_lshl_add_u32 v2, v0, 2, s8
  s_lshr_b32 s7, s5, 1
  s_lshl_b32 s8, s4, 4
  s_add_u32 s7, s7, s8
  s_lshl_b32 s6, s4, 5
  s_add_u32 s6, s6, s5
  s_lshl_b32 s12, s7, 1
  s_add_u32 s12, s12, s9
  s_mul_i32 s12, s12, 7168
  v_lshrrev_b32 v7, 3, v0
  v_lshrrev_b32 v8, 4, v0
  s_lshl_b32 s8, s9, 2
  v_add_u32 v8, s8, v8
  v_and_b32 v4, 7, v0
  v_xor_b32 v8, v4, v8
  v_mul_u32_u24 v7, 896, v7
  v_lshl_add_u32 v5, v8, 4, v7
  v_add_u32 v5, s12, v5
  s_lshl_b32 s11, s3, 10
  v_add_u32 v6, s11, v15
  s_add_u32 s15, s11, 28672
  s_lshr_b32 s8, s5, 1
  s_cmp_ge_u32 s8, 7
  s_cselect_b32 s12, 7, 0
  s_sub_u32 s8, s8, s12
  s_cmp_ge_u32 s8, 7
  s_cselect_b32 s12, 7, 0
  s_sub_u32 s8, s8, s12
  s_lshl_b32 s70, s8, 12
  s_waitcnt lgkmcnt(0)
  s_mov_b32 s56, s44
  s_mov_b32 s57, s45
  s_mov_b32 s58, 0x800000
  s_mov_b32 s59, 0x20000
  buffer_load_dword v54, off, s[56:59], 0 offset:0 sc1
  s_mov_b32 s48, s30
  s_mov_b32 s49, s31
  s_mov_b32 s50, 0x1c0000
  s_mov_b32 s51, 0x20000
  s_bitcmp1_b32 s6, 0
  s_cselect_b32 s52, s36, s34
  s_cselect_b32 s53, s37, s35
  s_mov_b32 s54, 25088
  s_mov_b32 s55, 0x20000
  s_cmp_ge_u32 s4, 4
  s_cbranch_scc1 L_pr_5
  s_mul_i32 s12, s10, 384
  s_mul_i32 s13, s10, 6144
  s_lshl_b32 s8, s9, 10
  s_add_u32 s13, s13, s8
  s_add_u32 m0, s13, 0
  s_nop 0
  buffer_load_dwordx4 v5, s[48:51], s12 offen lds
  s_add_u32 s12, s12, 128
  s_add_u32 m0, s13, 2048
  s_nop 0
  buffer_load_dwordx4 v5, s[48:51], s12 offen lds
  s_add_u32 s12, s12, 128
  s_add_u32 m0, s13, 4096
  s_nop 0
  buffer_load_dwordx4 v5, s[48:51], s12 offen lds
  s_add_u32 s12, s12, 128
  s_add_u32 m0, s13, 6144
  s_nop 0
  buffer_load_dwordx4 v5, s[48:51], s12 offen lds
  s_add_u32 m0, s15, s70
  s_nop 0
  buffer_load_dwordx4 v6, s[52:55], s70 offen lds
  s_add_u32 s70, s70, 4096
  s_cmp_eq_u32 s70, 28672
  s_cselect_b32 s70, 0, s70
  s_add_u32 m0, s15, s70
  s_nop 0
  buffer_load_dwordx4 v6, s[52:55], s70 offen lds
  s_add_u32 s70, s70, 4096
  s_cmp_eq_u32 s70, 28672
  s_cselect_b32 s70, 0, s70
  s_add_u32 m0, s15, s70
  s_nop 0
  buffer_load_dwordx4 v6, s[52:55], s70 offen lds
  s_add_u32 s70, s70, 4096
  s_cmp_eq_u32 s70, 28672
  s_cselect_b32 s70, 0, s70
  s_add_u32 m0, s15, s70
  s_nop 0
  buffer_load_dwordx4 v6, s[52:55], s70 offen lds
  s_add_u32 s70, s70, 4096
  s_cmp_eq_u32 s70, 28672
  s_cselect_b32 s70, 0, s70
  s_add_u32 m0, s15, s70
  s_nop 0
  buffer_load_dwordx4 v6, s[52:55], s70 offen lds
  s_add_u32 s70, s70, 4096
  s_cmp_eq_u32 s70, 28672
  s_cselect_b32 s70, 0, s70
  s_add_u32 m0, s15, s70
  s_nop 0
  buffer_load_dwordx4 v6, s[52:55], s70 offen lds
  s_add_u32 s70, s70, 4096
  s_cmp_eq_u32 s70, 28672
  s_cselect_b32 s70, 0, s70
  s_add_u32 m0, s15, s70
  s_nop 0
  buffer_load_dwordx4 v6, s[52:55], s70 offen lds
L_pr_5:
  s_cmp_ge_u32 s5, 28
  s_cbranch_scc1 L_ni_8
  global_load_dword v16, v2, s[18:19]
  global_load_dword v17, v2, s[20:21]
  global_load_dword v18, v2, s[22:23]
  global_load_dword v19, v2, s[24:25]
  s_load_dword s71, s[26:27], s14
  s_load_dword s72, s[28:29], s14
L_ni_8:
  s_getpc_b64 s[12:13]
L_pc_9:
  s_add_u32 s12, s12, concat_heads__ssm_conv_s4d__grouped_kv_mqa__prompt_kernel-L_pc_9
  s_addc_u32 s13, s13, -1
  s_lshl_b32 s8, s5, 2
  s_add_u32 s8, s8, s3
  s_mul_i32 s8, s8, 320
  v_mul_u32_u24 v9, 5, v0
  v_add_u32 v9, s8, v9
  v_and_b32 v9, -4, v9
  v_min_u32 v9, L_table-4-concat_heads__ssm_conv_s4d__grouped_kv_mqa__prompt_kernel, v9
  global_load_dword v55, v9, s[12:13]
  s_and_b32 s68, s7, 1
  v_and_b32 v2, 15, v0
  v_bfe_u32 v4, v2, 1, 3
  v_lshrrev_b32 v9, 4, v0
  v_xor_b32 v4, v4, v9
  v_lshlrev_b32 v3, 7, v2
  v_lshl_add_u32 v10, v4, 4, v3
  v_xor_b32 v4, 4, v4
  v_lshl_add_u32 v11, v4, 4, v3
  v_bfe_u32 v3, v0, 2, 2
  v_lshl_add_u32 v3, v9, 3, v3
  v_mul_u32_u24 v3, 56, v3
  v_and_b32 v4, 3, v0
  v_lshl_add_u32 v3, v4, 3, v3
  s_lshl_b32 s8, s3, 5
  s_add_u32 s8, s8, 28672
  v_add_u32 v12, s8, v3
  v_lshlrev_b32 v13, 4, v2
  v_bfe_u32 v3, v0, 4, 1
  v_lshl_add_u32 v13, v3, 9, v13
  s_bitcmp1_b32 s6, 0
  s_cselect_b32 s12, s68, s3
  s_cselect_b32 s13, s3, s68
  s_cselect_b32 s8, 2048, 0
  s_lshl_b32 s12, s12, 10
  s_lshl_b32 s13, s13, 8
  s_add_u32 s12, s12, s13
  s_add_u32 s12, s12, s8
  s_lshr_b32 s13, s7, 1
  s_lshl_b32 s13, s13, 12
  s_add_u32 s12, s12, s13
  s_add_u32 s69, s12, 65536
  s_lshr_b32 s8, s6, 3
  s_lshl_b32 s8, s8, 7
  s_and_b32 s12, s6, 7
  s_lshl_b32 s12, s12, 2
  s_add_u32 s8, s8, s12
  s_add_u32 s68, s8, 524288
  v_lshlrev_b32 v14, 12, v0
  s_cmp_ge_u32 s5, 28
  s_cbranch_scc1 L_idle_2
  s_setprio 0
  s_mov_b32 s64, s16
  s_mov_b32 s65, s17
  s_mov_b32 s66, 0x1c0000
  s_mov_b32 s67, 0x20000
  s_mov_b32 s60, s40
  s_mov_b32 s61, s41
  s_mov_b32 s62, 0x380000
  s_mov_b32 s63, 0x20000
  s_lshl_b32 s8, s9, 12
  v_add_u32 v1, s8, v15
  s_lshl_b32 s8, s96, 6
  s_lshl_b32 s12, s3, 4
  s_add_u32 s8, s8, s12
  s_mul_i32 s8, s8, 896
  s_lshl_b32 s12, s73, 7
  s_add_u32 s8, s8, s12
  v_and_b32 v20, 7, v0
  v_lshl_add_u32 v7, v20, 4, v7
  v_add_u32 v7, s8, v7
  s_lshl_b32 s8, s74, 12
  s_lshl_b32 s12, s9, 11
  s_add_u32 s8, s8, s12
  s_add_u32 s14, s8, 3145728
  s_add_u32 s92, s8, 5242880
  s_mul_i32 s11, s10, 4608
  s_add_u32 s11, s11, 61440
  s_mul_i32 s8, s10, 4160
  s_add_u32 s75, s8, 70656
  s_add_u32 s12, s12, s75
  v_lshl_add_u32 v243, v0, 5, s12
  v_lshl_add_u32 v244, v0, 2, s75
  v_bfe_u32 v2, v0, 1, 2
  v_mul_u32_u24 v2, 1152, v2
  v_lshrrev_b32 v21, 3, v0
  v_lshl_add_u32 v2, v21, 5, v2
  v_and_b32 v4, 1, v0
  v_lshl_add_u32 v2, v4, 4, v2
  s_lshl_b32 s12, s9, 9
  s_add_u32 s12, s12, s11
  v_add_u32 v232, s12, v2
  v_mul_u32_u24 v3, 1152, v21
  v_lshl_add_u32 v3, v20, 4, v3
  v_add_u32 v233, s11, v3
  v_lshlrev_b32 v4, 4, v4
  v_bfe_u32 v8, v0, 1, 1
  v_lshl_add_u32 v4, v8, 2, v4
  v_bfe_u32 v8, v0, 4, 1
  v_lshl_add_u32 v4, v8, 3, v4
  v_lshrrev_b32 v22, 5, v0
  v_lshlrev_b32 v8, 5, v22
  v_sub_u32 v4, v4, v8
  v_bfe_u32 v23, v0, 2, 2
  v_lshlrev_b32 v8, 2, v23
  v_sub_u32 v4, v4, v8
  s_add_u32 s12, s75, 96
  v_lshl_add_u32 v234, v4, 1, s12
  v_bfe_u32 v4, v0, 3, 2
  v_mul_u32_u24 v3, 1152, v4
  v_add_u32 v8, v20, v22
  v_lshl_add_u32 v3, v8, 4, v3
  s_add_u32 s12, s11, 16
  v_add_u32 v235, s12, v3
  v_lshrrev_b32 v8, 1, v20
  v_and_b32 v3, 1, v20
  v_lshl_or_b32 v8, v3, 2, v8
  v_lshlrev_b32 v3, 2, v22
  v_xor_b32 v8, v8, v3
  v_lshlrev_b32 v4, 13, v4
  v_lshl_add_u32 v4, v20, 7, v4
  s_lshl_b32 s13, s10, 15
  v_add_u32 v4, s13, v4
  v_xor_b32 v3, 0, v8
  v_lshl_add_u32 v236, v3, 4, v4
  v_xor_b32 v3, 1, v8
  v_lshl_add_u32 v237, v3, 4, v4
  v_xor_b32 v3, 2, v8
  v_lshl_add_u32 v238, v3, 4, v4
  v_xor_b32 v3, 3, v8
  v_lshl_add_u32 v239, v3, 4, v4
  s_lshl_b32 s12, s9, 7
  v_add_u32 v2, s12, v0
  v_lshrrev_b32 v3, 2, v2
  v_and_b32 v4, 3, v2
  v_lshlrev_b32 v4, 1, v4
  v_bfe_u32 v9, v3, 1, 2
  v_and_b32 v8, 1, v3
  v_lshl_or_b32 v9, v8, 2, v9
  v_xor_b32 v9, v9, v4
  v_lshlrev_b32 v2, 7, v3
  v_add_u32 v2, s13, v2
  v_lshl_add_u32 v240, v9, 4, v2
  v_xor_b32 v9, 1, v9
  v_lshl_add_u32 v241, v9, 4, v2
  v_lshl_add_u32 v4, v3, 3, v4
  v_add_u32 v4, -1, v4
  v_ashrrev_i32 v3, 3, v4
  v_and_b32 v4, 7, v4
  v_bfe_u32 v9, v3, 1, 2
  v_and_b32 v8, 1, v3
  v_lshl_or_b32 v9, v8, 2, v9
  v_xor_b32 v9, v9, v4
  v_lshlrev_b32 v2, 7, v3
  v_add_u32 v2, s13, v2
  v_lshl_add_u32 v2, v9, 4, v2
  v_add_u32 v242, 8192, v2
  s_cmp_eq_u32 s9, 0
  s_cselect_b32 s93, 1, 0
  v_lshrrev_b32 v3, 4, v0
  v_lshl_add_u32 v2, v23, 2, v3
  v_lshlrev_b32 v2, 7, v2
  v_and_b32 v9, 3, v0
  v_lshl_add_u32 v2, v9, 3, v2
  s_lshl_b32 s8, s3, 5
  s_add_u32 s8, s8, 0
  v_add_u32 v246, s8, v2
  s_mul_i32 s12, s3, 2304
  s_add_u32 s12, s12, 8192
  v_and_b32 v4, 15, v0
  v_mul_u32_u24 v4, 144, v4
  v_lshl_add_u32 v4, v3, 5, v4
  v_add_u32 v247, s12, v4
  v_lshlrev_b32 v4, 4, v20
  v_mul_u32_u24 v2, 144, v21
  v_add3_u32 v248, v2, v4, s12
  s_lshl_b32 s8, s73, 2
  s_add_u32 s8, s8, s3
  s_lshl_b32 s8, s8, 16
  s_lshl_b32 s12, s96, 7
  s_add_u32 s8, s8, s12
  s_add_u32 s8, s8, 3145728
  v_lshl_add_u32 v251, v21, 12, v4
  v_add_u32 v249, s8, v251
  v_add_u32 v250, 32768, v249
  s_lshl_b32 s36, s73, 9
  s_add_u32 s36, s36, 36864
  s_lshl_b32 s8, s96, 2
  s_add_u32 s35, s36, s8
  s_lshl_b32 s8, s73, 6
  s_lshl_b32 s13, s3, 3
  s_add_u32 s8, s8, s13
  s_lshl_b32 s8, s8, 12
  s_add_u32 s8, s8, s12
  s_add_u32 s37, s8, 5242880
  s_add_u32 s38, s37, 131072
  v_add_u32 v2, s13, v21
  v_mul_u32_u24 v2, 160, v2
  v_add_u32 v252, v2, v4
  v_lshl_add_u32 v2, v3, 3, v23
  v_mul_u32_u24 v2, 160, v2
  v_lshl_add_u32 v2, v9, 3, v2
  s_lshl_b32 s8, s3, 5
  v_add_u32 v253, s8, v2
  s_lshl_b32 s8, s96, 2
  s_add_u32 s8, s8, s3
  s_mul_i32 s39, s8, 28672
  s_lshl_b32 s8, s73, 7
  s_add_u32 s39, s39, s8
  s_add_u32 s94, s39, 14336
  v_mul_u32_u24 v2, 1792, v21
  v_add_u32 v254, v2, v4
  v_and_b32 v2, 15, v0
  v_mul_u32_u24 v2, 144, v2
  v_lshl_add_u32 v2, v3, 4, v2
  s_mul_i32 s8, s3, 2304
  s_add_u32 s8, s8, 12288
  v_add_u32 v255, s8, v2
  s_mul_i32 s11, s3, 15360
  v_mul_u32_u24 v2, 240, v0
  v_add_u32 v2, s11, v2
  v_lshl_add_u32 v3, v23, 1, v22
  v_mul_u32_u24 v3, 480, v3
  v_bfe_u32 v8, v0, 4, 1
  v_lshl_add_u32 v3, v8, 5, v3
  v_lshl_add_u32 v3, v9, 3, v3
  v_add_u32 v3, s11, v3
  v_and_b32 v4, 31, v0
  v_mul_u32_u24 v4, 144, v4
  v_lshl_add_u32 v4, v22, 4, v4
  v_add_u32 v4, s11, v4
  s_setprio 3
  s_waitcnt vmcnt(5) lgkmcnt(0)
  v_readfirstlane_b32 s46, v54
  s_nop 0
  s_add_u32 s46, s46, 0x9e3779b9
  s_cmp_ge_u32 s4, 4
  s_cbranch_scc1 L_ekv_10
  s_waitcnt vmcnt(5)
  s_barrier
  s_cmp_ge_u32 s3, 2
  s_cbranch_scc1 L_kvb_11
  ds_read_b128 v[56:59], v10 offset:0
  ds_read_b64_tr_b16 v[60:61], v12 offset:0
  ds_read_b64_tr_b16 v[62:63], v12 offset:224
  ds_read_b128 v[64:67], v11 offset:0
  ds_read_b64_tr_b16 v[68:69], v12 offset:1792
  ds_read_b64_tr_b16 v[70:71], v12 offset:2016
  ds_read_b128 v[72:75], v10 offset:2048
  ds_read_b64_tr_b16 v[76:77], v12 offset:3584
  ds_read_b64_tr_b16 v[78:79], v12 offset:3808
  ds_read_b128 v[80:83], v11 offset:2048
  ds_read_b64_tr_b16 v[84:85], v12 offset:5376
  ds_read_b64_tr_b16 v[86:87], v12 offset:5600
  s_bitcmp1_b32 s6, 0
  s_cbranch_scc1 L_kvV_13
  ds_read_b128 v[88:91], v10 offset:4096
  ds_read_b64_tr_b16 v[92:93], v12 offset:7168
  ds_read_b64_tr_b16 v[94:95], v12 offset:7392
  s_waitcnt lgkmcnt(12)
  v_mfma_f32_16x16x32_bf16 v[100:103], v[60:63], v[56:59], 0
  ds_read_b128 v[56:59], v11 offset:4096
  ds_read_b64_tr_b16 v[60:61], v12 offset:8960
  ds_read_b64_tr_b16 v[62:63], v12 offset:9184
  s_waitcnt lgkmcnt(12)
  v_mfma_f32_16x16x32_bf16 v[100:103], v[68:71], v[64:67], v[100:103]
  ds_read_b128 v[64:67], v10 offset:6144
  ds_read_b64_tr_b16 v[68:69], v12 offset:10752
  ds_read_b64_tr_b16 v[70:71], v12 offset:10976
  s_waitcnt lgkmcnt(12)
  v_mfma_f32_16x16x32_bf16 v[100:103], v[76:79], v[72:75], v[100:103]
  ds_read_b128 v[72:75], v11 offset:6144
  ds_read_b64_tr_b16 v[76:77], v12 offset:12544
  ds_read_b64_tr_b16 v[78:79], v12 offset:12768
  s_waitcnt lgkmcnt(12)
  v_mfma_f32_16x16x32_bf16 v[100:103], v[84:87], v[80:83], v[100:103]
  ds_read_b128 v[80:83], v10 offset:8192
  ds_read_b64_tr_b16 v[84:85], v12 offset:14336
  ds_read_b64_tr_b16 v[86:87], v12 offset:14560
  s_waitcnt lgkmcnt(12)
  v_mfma_f32_16x16x32_bf16 v[100:103], v[92:95], v[88:91], v[100:103]
  ds_read_b128 v[88:91], v11 offset:8192
  ds_read_b64_tr_b16 v[92:93], v12 offset:16128
  ds_read_b64_tr_b16 v[94:95], v12 offset:16352
  s_waitcnt lgkmcnt(12)
  v_mfma_f32_16x16x32_bf16 v[100:103], v[60:63], v[56:59], v[100:103]
  ds_read_b128 v[56:59], v10 offset:10240
  ds_read_b64_tr_b16 v[60:61], v12 offset:17920
  ds_read_b64_tr_b16 v[62:63], v12 offset:18144
  s_waitcnt lgkmcnt(12)
  v_mfma_f32_16x16x32_bf16 v[100:103], v[68:71], v[64:67], v[100:103]
  ds_read_b128 v[64:67], v11 offset:10240
  ds_read_b64_tr_b16 v[68:69], v12 offset:19712
  ds_read_b64_tr_b16 v[70:71], v12 offset:19936
  s_waitcnt lgkmcnt(12)
  v_mfma_f32_16x16x32_bf16 v[100:103], v[76:79], v[72:75], v[100:103]
  ds_read_b128 v[72:75], v10 offset:12288
  ds_read_b64_tr_b16 v[76:77], v12 offset:21504
  ds_read_b64_tr_b16 v[78:79], v12 offset:21728
  s_waitcnt lgkmcnt(12)
  v_mfma_f32_16x16x32_bf16 v[100:103], v[84:87], v[80:83], v[100:103]
  ds_read_b128 v[80:83], v11 offset:12288
  ds_read_b64_tr_b16 v[84:85], v12 offset:23296
  ds_read_b64_tr_b16 v[86:87], v12 offset:23520
  s_waitcnt lgkmcnt(12)
  v_mfma_f32_16x16x32_bf16 v[100:103], v[92:95], v[88:91], v[100:103]
  s_waitcnt lgkmcnt(9)
  v_mfma_f32_16x16x32_bf16 v[100:103], v[60:63], v[56:59], v[100:103]
  s_waitcnt lgkmcnt(6)
  v_mfma_f32_16x16x32_bf16 v[100:103], v[68:71], v[64:67], v[100:103]
  s_waitcnt lgkmcnt(3)
  v_mfma_f32_16x16x32_bf16 v[100:103], v[76:79], v[72:75], v[100:103]
  s_waitcnt lgkmcnt(0)
  v_mfma_f32_16x16x32_bf16 v[100:103], v[84:87], v[80:83], v[100:103]
  s_cmp_eq_u32 s3, 1
  s_cselect_b32 s12, 0xffff0000, 0
  s_nop 5
  v_mul_f32 v100, 0x3e8b97f6, v100
  v_mul_f32 v101, 0x3e8b97f6, v101
  v_mul_f32 v102, 0x3e8b97f6, v102
  v_mul_f32 v103, 0x3e8b97f6, v103
  v_cvt_pk_bf16_f32 v96, v100, v101
  v_cvt_pk_bf16_f32 v97, v102, v103
  s_mov_b32 exec_lo, 0
  s_mov_b32 exec_hi, s12
  v_mov_b32 v96, 0x3f803f80
  v_mov_b32 v97, 0x00003f80
  s_mov_b64 exec, -1
  s_branch L_kvst_14
L_kvV_13:
  ds_read_b128 v[88:91], v10 offset:4096
  ds_read_b64_tr_b16 v[92:93], v12 offset:7168
  ds_read_b64_tr_b16 v[94:95], v12 offset:7392
  s_waitcnt lgkmcnt(12)
  v_mfma_f32_16x16x32_bf16 v[100:103], v[56:59], v[60:63], 0
  ds_read_b128 v[56:59], v11 offset:4096
  ds_read_b64_tr_b16 v[60:61], v12 offset:8960
  ds_read_b64_tr_b16 v[62:63], v12 offset:9184
  s_waitcnt lgkmcnt(12)
  v_mfma_f32_16x16x32_bf16 v[100:103], v[64:67], v[68:71], v[100:103]
  ds_read_b128 v[64:67], v10 offset:6144
  ds_read_b64_tr_b16 v[68:69], v12 offset:10752
  ds_read_b64_tr_b16 v[70:71], v12 offset:10976
  s_waitcnt lgkmcnt(12)
  v_mfma_f32_16x16x32_bf16 v[100:103], v[72:75], v[76:79], v[100:103]
  ds_read_b128 v[72:75], v11 offset:6144
  ds_read_b64_tr_b16 v[76:77], v12 offset:12544
  ds_read_b64_tr_b16 v[78:79], v12 offset:12768
  s_waitcnt lgkmcnt(12)
  v_mfma_f32_16x16x32_bf16 v[100:103], v[80:83], v[84:87], v[100:103]
  ds_read_b128 v[80:83], v10 offset:8192
  ds_read_b64_tr_b16 v[84:85], v12 offset:14336
  ds_read_b64_tr_b16 v[86:87], v12 offset:14560
  s_waitcnt lgkmcnt(12)
  v_mfma_f32_16x16x32_bf16 v[100:103], v[88:91], v[92:95], v[100:103]
  ds_read_b128 v[88:91], v11 offset:8192
  ds_read_b64_tr_b16 v[92:93], v12 offset:16128
  ds_read_b64_tr_b16 v[94:95], v12 offset:16352
  s_waitcnt lgkmcnt(12)
  v_mfma_f32_16x16x32_bf16 v[100:103], v[56:59], v[60:63], v[100:103]
  ds_read_b128 v[56:59], v10 offset:10240
  ds_read_b64_tr_b16 v[60:61], v12 offset:17920
  ds_read_b64_tr_b16 v[62:63], v12 offset:18144
  s_waitcnt lgkmcnt(12)
  v_mfma_f32_16x16x32_bf16 v[100:103], v[64:67], v[68:71], v[100:103]
  ds_read_b128 v[64:67], v11 offset:10240
  ds_read_b64_tr_b16 v[68:69], v12 offset:19712
  ds_read_b64_tr_b16 v[70:71], v12 offset:19936
  s_waitcnt lgkmcnt(12)
  v_mfma_f32_16x16x32_bf16 v[100:103], v[72:75], v[76:79], v[100:103]
  ds_read_b128 v[72:75], v10 offset:12288
  ds_read_b64_tr_b16 v[76:77], v12 offset:21504
  ds_read_b64_tr_b16 v[78:79], v12 offset:21728
  s_waitcnt lgkmcnt(12)
  v_mfma_f32_16x16x32_bf16 v[100:103], v[80:83], v[84:87], v[100:103]
  ds_read_b128 v[80:83], v11 offset:12288
  ds_read_b64_tr_b16 v[84:85], v12 offset:23296
  ds_read_b64_tr_b16 v[86:87], v12 offset:23520
  s_waitcnt lgkmcnt(12)
  v_mfma_f32_16x16x32_bf16 v[100:103], v[88:91], v[92:95], v[100:103]
  s_waitcnt lgkmcnt(9)
  v_mfma_f32_16x16x32_bf16 v[100:103], v[56:59], v[60:63], v[100:103]
  s_waitcnt lgkmcnt(6)
  v_mfma_f32_16x16x32_bf16 v[100:103], v[64:67], v[68:71], v[100:103]
  s_waitcnt lgkmcnt(3)
  v_mfma_f32_16x16x32_bf16 v[100:103], v[72:75], v[76:79], v[100:103]
  s_waitcnt lgkmcnt(0)
  v_mfma_f32_16x16x32_bf16 v[100:103], v[80:83], v[84:87], v[100:103]
  s_cmp_eq_u32 s3, 1
  s_cselect_b32 s12, 0xe000e000, 0
  s_cselect_b32 s13, 0x10001000, 0
  s_nop 4
  v_cvt_pk_bf16_f32 v96, v100, v101
  v_cvt_pk_bf16_f32 v97, v102, v103
  s_mov_b32 exec_lo, s12
  s_mov_b32 exec_hi, s12
  v_mov_b32 v96, 0
  v_mov_b32 v97, 0
  s_mov_b32 exec_lo, s13
  s_mov_b32 exec_hi, s13
  v_mov_b32 v96, 0x3f803f80
  v_mov_b32 v97, 0x3f803f80
  s_mov_b64 exec, -1
L_kvst_14:
  s_nop 1
  v_permlane32_swap_b32 v96, v98
  v_permlane32_swap_b32 v97, v99
  s_mov_b32 exec_hi, 0
  buffer_store_dwordx4 v[96:99], v13, s[56:59], s69 offen sc1
  s_mov_b32 exec_hi, -1
L_kvb_11:
  v_mov_b32 v33, s46
  s_waitcnt vmcnt(0)
  s_barrier
  s_cmp_lg_u32 s3, 0
  s_cbranch_scc1 L_kvf_12
  s_mov_b64 exec, 0xffffffff
  buffer_store_dword v33, v14, s[56:59], s68 offen sc1
  s_mov_b64 exec, -1
L_kvf_12:
L_ekv_10:
  s_cmp_eq_u32 s10, 1
  s_cselect_b32 s8, 0, 16
  s_lshl_b32 s12, s71, s8
  s_and_b32 s12, s12, 0xffff0000
  s_lshl_b32 s13, s72, s8
  s_and_b32 s72, s13, 0xffff0000
  v_mov_b32 v31, s12
  v_mul_f32 v31, 0x3fb8aa3b, v31
  v_exp_f32 v31, v31
  v_mov_b32 v245, 0
  v_cvt_pk_bf16_f32 v31, v31, v31
  v_and_b32 v31, 0xffff0000, v31
  v_mul_f32 v32, 0xbfb8aa3b, v31
  v_mul_f32 v30, 0.15915494309189532, v31
  v_add_f32 v31, v31, v31
  s_mov_b32 exec_lo, s93
  s_mov_b32 exec_hi, 0
  v_mov_b32 v245, s72
  s_mov_b64 exec, -1
  s_cmp_ge_u32 s4, 4
  s_cbranch_scc1 L_wp_15
  s_cmp_ge_u32 s3, 2
  s_cbranch_scc1 L_wp_15
  s_waitcnt vmcnt(2)
  s_branch L_wp_16
L_wp_15:
  s_waitcnt vmcnt(1)
L_wp_16:
  v_lshlrev_b32 v20, 16, v16
  v_lshlrev_b32 v21, 16, v17
  v_lshlrev_b32 v34, 16, v18
  v_lshlrev_b32 v35, 16, v19
  v_mul_f32 v20, 0x3fb8aa3b, v20
  v_exp_f32 v20, v20
  v_mul_f32 v21, v21, v30
  v_cvt_pk_bf16_f32 v20, v20, v20
  v_and_b32 v20, 0xffff0000, v20
  v_mul_f32 v20, v20, v32
  v_mul_f32 v34, v34, v31
  v_mul_f32 v35, -v35, v31
  v_exp_f32 v22, v20
  v_fract_f32 v23, v21
  v_cos_f32 v24, v23
  v_sin_f32 v25, v23
  v_mul_f32 v24, v24, v22
  v_mul_f32 v25, v25, v22
  v_mul_f32 v22, 0x43800000, v20
  v_mul_f32 v23, 0x43800000, v21
  v_exp_f32 v22, v22
  v_fract_f32 v23, v23
  v_cos_f32 v26, v23
  v_sin_f32 v27, v23
  v_mul_f32 v26, v26, v22
  v_mul_f32 v27, v27, v22
  v_mul_f32 v22, 0x41000000, v20
  v_mul_f32 v23, 0x41000000, v21
  v_exp_f32 v22, v22
  v_fract_f32 v23, v23
  v_cos_f32 v28, v23
  v_sin_f32 v29, v23
  v_mul_f32 v28, v28, v22
  v_mul_f32 v29, v29, v22
  v_pk_mul_f32 v[52:53], v[34:35], v[24:25] op_sel_hi:[1,0]
  v_pk_fma_f32 v[42:43], v[34:35], v[24:25], v[52:53] op_sel:[1,1,0] op_sel_hi:[0,1,1] neg_hi:[1,0,0]
  v_cvt_pk_bf16_f32 v152, v34, v42
  v_cvt_pk_bf16_f32 v156, v35, v43
  v_pk_mul_f32 v[52:53], v[42:43], v[24:25] op_sel_hi:[1,0]
  v_pk_fma_f32 v[36:37], v[42:43], v[24:25], v[52:53] op_sel:[1,1,0] op_sel_hi:[0,1,1] neg_hi:[1,0,0]
  v_pk_mul_f32 v[52:53], v[36:37], v[24:25] op_sel_hi:[1,0]
  v_pk_fma_f32 v[42:43], v[36:37], v[24:25], v[52:53] op_sel:[1,1,0] op_sel_hi:[0,1,1] neg_hi:[1,0,0]
  v_cvt_pk_bf16_f32 v153, v36, v42
  v_cvt_pk_bf16_f32 v157, v37, v43
  v_pk_mul_f32 v[52:53], v[42:43], v[24:25] op_sel_hi:[1,0]
  v_pk_fma_f32 v[38:39], v[42:43], v[24:25], v[52:53] op_sel:[1,1,0] op_sel_hi:[0,1,1] neg_hi:[1,0,0]
  v_pk_mul_f32 v[52:53], v[38:39], v[24:25] op_sel_hi:[1,0]
  v_pk_fma_f32 v[42:43], v[38:39], v[24:25], v[52:53] op_sel:[1,1,0] op_sel_hi:[0,1,1] neg_hi:[1,0,0]
  v_cvt_pk_bf16_f32 v154, v38, v42
  v_cvt_pk_bf16_f32 v158, v39, v43
  v_pk_mul_f32 v[52:53], v[42:43], v[24:25] op_sel_hi:[1,0]
  v_pk_fma_f32 v[40:41], v[42:43], v[24:25], v[52:53] op_sel:[1,1,0] op_sel_hi:[0,1,1] neg_hi:[1,0,0]
  v_pk_mul_f32 v[52:53], v[40:41], v[24:25] op_sel_hi:[1,0]
  v_pk_fma_f32 v[42:43], v[40:41], v[24:25], v[52:53] op_sel:[1,1,0] op_sel_hi:[0,1,1] neg_hi:[1,0,0]
  v_cvt_pk_bf16_f32 v155, v40, v42
  v_cvt_pk_bf16_f32 v159, v41, v43
  v_pk_mul_f32 v[52:53], v[34:35], v[26:27] op_sel_hi:[1,0]
  v_pk_fma_f32 v[34:35], v[34:35], v[26:27], v[52:53] op_sel:[1,1,0] op_sel_hi:[0,1,1] neg_hi:[1,0,0]
  v_pk_mul_f32 v[52:53], v[36:37], v[26:27] op_sel_hi:[1,0]
  v_pk_fma_f32 v[36:37], v[36:37], v[26:27], v[52:53] op_sel:[1,1,0] op_sel_hi:[0,1,1] neg_hi:[1,0,0]
  v_cvt_pk_bf16_f32 v160, v34, v36
  v_cvt_pk_bf16_f32 v164, v35, v37
  v_pk_mul_f32 v[52:53], v[38:39], v[26:27] op_sel_hi:[1,0]
  v_pk_fma_f32 v[38:39], v[38:39], v[26:27], v[52:53] op_sel:[1,1,0] op_sel_hi:[0,1,1] neg_hi:[1,0,0]
  v_pk_mul_f32 v[52:53], v[40:41], v[26:27] op_sel_hi:[1,0]
  v_pk_fma_f32 v[40:41], v[40:41], v[26:27], v[52:53] op_sel:[1,1,0] op_sel_hi:[0,1,1] neg_hi:[1,0,0]
  v_cvt_pk_bf16_f32 v161, v38, v40
  v_cvt_pk_bf16_f32 v165, v39, v41
  v_pk_mul_f32 v[52:53], v[34:35], v[26:27] op_sel_hi:[1,0]
  v_pk_fma_f32 v[34:35], v[34:35], v[26:27], v[52:53] op_sel:[1,1,0] op_sel_hi:[0,1,1] neg_hi:[1,0,0]
  v_pk_mul_f32 v[52:53], v[38:39], v[26:27] op_sel_hi:[1,0]
  v_pk_fma_f32 v[38:39], v[38:39], v[26:27], v[52:53] op_sel:[1,1,0] op_sel_hi:[0,1,1] neg_hi:[1,0,0]
  v_cvt_pk_bf16_f32 v162, v34, v38
  v_cvt_pk_bf16_f32 v166, v35, v39
  v_pk_mul_f32 v[52:53], v[34:35], v[26:27] op_sel_hi:[1,0]
  v_pk_fma_f32 v[34:35], v[34:35], v[26:27], v[52:53] op_sel:[1,1,0] op_sel_hi:[0,1,1] neg_hi:[1,0,0]
  v_pk_mul_f32 v[52:53], v[38:39], v[26:27] op_sel_hi:[1,0]
  v_pk_fma_f32 v[38:39], v[38:39], v[26:27], v[52:53] op_sel:[1,1,0] op_sel_hi:[0,1,1] neg_hi:[1,0,0]
  v_cvt_pk_bf16_f32 v163, v34, v38
  v_cvt_pk_bf16_f32 v167, v35, v39
  v_pk_mul_f32 v[52:53], v[34:35], v[26:27] op_sel_hi:[1,0]
  v_pk_fma_f32 v[42:43], v[34:35], v[26:27], v[52:53] op_sel:[1,1,0] op_sel_hi:[0,1,1] neg_hi:[1,0,0]
  v_pk_mul_f32 v[52:53], v[42:43], v[26:27] op_sel_hi:[1,0]
  v_pk_fma_f32 v[44:45], v[42:43], v[26:27], v[52:53] op_sel:[1,1,0] op_sel_hi:[0,1,1] neg_hi:[1,0,0]
  v_cvt_pk_bf16_f32 v168, v42, v44
  v_cvt_pk_bf16_f32 v172, v43, v45
  v_pk_mul_f32 v[52:53], v[44:45], v[26:27] op_sel_hi:[1,0]
  v_pk_fma_f32 v[42:43], v[44:45], v[26:27], v[52:53] op_sel:[1,1,0] op_sel_hi:[0,1,1] neg_hi:[1,0,0]
  v_pk_mul_f32 v[52:53], v[42:43], v[26:27] op_sel_hi:[1,0]
  v_pk_fma_f32 v[44:45], v[42:43], v[26:27], v[52:53] op_sel:[1,1,0] op_sel_hi:[0,1,1] neg_hi:[1,0,0]
  v_cvt_pk_bf16_f32 v169, v42, v44
  v_cvt_pk_bf16_f32 v173, v43, v45
  v_pk_mul_f32 v[52:53], v[44:45], v[26:27] op_sel_hi:[1,0]
  v_pk_fma_f32 v[42:43], v[44:45], v[26:27], v[52:53] op_sel:[1,1,0] op_sel_hi:[0,1,1] neg_hi:[1,0,0]
  v_cvt_pk_bf16_f32 v170, v42, v42
  v_cvt_pk_bf16_f32 v174, v43, v43
  v_mov_b32 v171, 0
  v_mov_b32 v175, 0
  s_setprio 2
  s_getpc_b64 s[12:13]
L_pc_17:
  s_add_u32 s12, s12, L_table-L_pc_17
  s_addc_u32 s13, s13, 0
  global_load_dwordx4 v[104:107], v1, s[12:13] offset:0
  global_load_dwordx4 v[108:111], v1, s[12:13] offset:1024
  global_load_dwordx4 v[112:115], v1, s[12:13] offset:2048
  global_load_dwordx4 v[116:119], v1, s[12:13] offset:3072
  v_cvt_pk_bf16_f32 v120, 1.0, v28
  v_cvt_pk_bf16_f32 v124, 0, v29
  v_pk_mul_f32 v[50:51], v[28:29], v[28:29] op_sel_hi:[1,0]
  v_pk_fma_f32 v[46:47], v[28:29], v[28:29], v[50:51] op_sel:[1,1,0] op_sel_hi:[0,1,1] neg_lo:[1,0,0]
  v_pk_mul_f32 v[50:51], v[46:47], v[28:29] op_sel_hi:[1,0]
  v_pk_fma_f32 v[48:49], v[46:47], v[28:29], v[50:51] op_sel:[1,1,0] op_sel_hi:[0,1,1] neg_lo:[1,0,0]
  v_cvt_pk_bf16_f32 v121, v46, v48
  v_cvt_pk_bf16_f32 v125, v47, v49
  v_pk_mul_f32 v[50:51], v[48:49], v[28:29] op_sel_hi:[1,0]
  v_pk_fma_f32 v[46:47], v[48:49], v[28:29], v[50:51] op_sel:[1,1,0] op_sel_hi:[0,1,1] neg_lo:[1,0,0]
  v_pk_mul_f32 v[50:51], v[46:47], v[28:29] op_sel_hi:[1,0]
  v_pk_fma_f32 v[48:49], v[46:47], v[28:29], v[50:51] op_sel:[1,1,0] op_sel_hi:[0,1,1] neg_lo:[1,0,0]
  v_cvt_pk_bf16_f32 v122, v46, v48
  v_cvt_pk_bf16_f32 v126, v47, v49
  v_pk_mul_f32 v[50:51], v[48:49], v[28:29] op_sel_hi:[1,0]
  v_pk_fma_f32 v[46:47], v[48:49], v[28:29], v[50:51] op_sel:[1,1,0] op_sel_hi:[0,1,1] neg_lo:[1,0,0]
  v_pk_mul_f32 v[50:51], v[46:47], v[28:29] op_sel_hi:[1,0]
  v_pk_fma_f32 v[48:49], v[46:47], v[28:29], v[50:51] op_sel:[1,1,0] op_sel_hi:[0,1,1] neg_lo:[1,0,0]
  v_cvt_pk_bf16_f32 v123, v46, v48
  v_cvt_pk_bf16_f32 v127, v47, v49
  v_pk_mul_f32 v[50:51], v[48:49], v[28:29] op_sel_hi:[1,0]
  v_pk_fma_f32 v[46:47], v[48:49], v[28:29], v[50:51] op_sel:[1,1,0] op_sel_hi:[0,1,1] neg_lo:[1,0,0]
  v_pk_mul_f32 v[50:51], v[46:47], v[28:29] op_sel_hi:[1,0]
  v_pk_fma_f32 v[48:49], v[46:47], v[28:29], v[50:51] op_sel:[1,1,0] op_sel_hi:[0,1,1] neg_lo:[1,0,0]
  v_cvt_pk_bf16_f32 v128, v46, v48
  v_cvt_pk_bf16_f32 v132, v47, v49
  v_pk_mul_f32 v[50:51], v[48:49], v[28:29] op_sel_hi:[1,0]
  v_pk_fma_f32 v[46:47], v[48:49], v[28:29], v[50:51] op_sel:[1,1,0] op_sel_hi:[0,1,1] neg_lo:[1,0,0]
  v_pk_mul_f32 v[50:51], v[46:47], v[28:29] op_sel_hi:[1,0]
  v_pk_fma_f32 v[48:49], v[46:47], v[28:29], v[50:51] op_sel:[1,1,0] op_sel_hi:[0,1,1] neg_lo:[1,0,0]
  v_cvt_pk_bf16_f32 v129, v46, v48
  v_cvt_pk_bf16_f32 v133, v47, v49
  v_pk_mul_f32 v[50:51], v[48:49], v[28:29] op_sel_hi:[1,0]
  v_pk_fma_f32 v[46:47], v[48:49], v[28:29], v[50:51] op_sel:[1,1,0] op_sel_hi:[0,1,1] neg_lo:[1,0,0]
  v_pk_mul_f32 v[50:51], v[46:47], v[28:29] op_sel_hi:[1,0]
  v_pk_fma_f32 v[48:49], v[46:47], v[28:29], v[50:51] op_sel:[1,1,0] op_sel_hi:[0,1,1] neg_lo:[1,0,0]
  v_cvt_pk_bf16_f32 v130, v46, v48
  v_cvt_pk_bf16_f32 v134, v47, v49
  v_pk_mul_f32 v[50:51], v[48:49], v[28:29] op_sel_hi:[1,0]
  v_pk_fma_f32 v[46:47], v[48:49], v[28:29], v[50:51] op_sel:[1,1,0] op_sel_hi:[0,1,1] neg_lo:[1,0,0]
  v_pk_mul_f32 v[50:51], v[46:47], v[28:29] op_sel_hi:[1,0]
  v_pk_fma_f32 v[48:49], v[46:47], v[28:29], v[50:51] op_sel:[1,1,0] op_sel_hi:[0,1,1] neg_lo:[1,0,0]
  v_cvt_pk_bf16_f32 v131, v46, v48
  v_cvt_pk_bf16_f32 v135, v47, v49
  v_pk_mul_f32 v[50:51], v[48:49], v[28:29] op_sel_hi:[1,0]
  v_pk_fma_f32 v[46:47], v[48:49], v[28:29], v[50:51] op_sel:[1,1,0] op_sel_hi:[0,1,1] neg_lo:[1,0,0]
  v_pk_mul_f32 v[50:51], v[46:47], v[28:29] op_sel_hi:[1,0]
  v_pk_fma_f32 v[48:49], v[46:47], v[28:29], v[50:51] op_sel:[1,1,0] op_sel_hi:[0,1,1] neg_lo:[1,0,0]
  v_cvt_pk_bf16_f32 v136, v46, v48
  v_cvt_pk_bf16_f32 v140, v47, v49
  v_pk_mul_f32 v[50:51], v[48:49], v[28:29] op_sel_hi:[1,0]
  v_pk_fma_f32 v[46:47], v[48:49], v[28:29], v[50:51] op_sel:[1,1,0] op_sel_hi:[0,1,1] neg_lo:[1,0,0]
  v_pk_mul_f32 v[50:51], v[46:47], v[28:29] op_sel_hi:[1,0]
  v_pk_fma_f32 v[48:49], v[46:47], v[28:29], v[50:51] op_sel:[1,1,0] op_sel_hi:[0,1,1] neg_lo:[1,0,0]
  v_cvt_pk_bf16_f32 v137, v46, v48
  v_cvt_pk_bf16_f32 v141, v47, v49
  v_pk_mul_f32 v[50:51], v[48:49], v[28:29] op_sel_hi:[1,0]
  v_pk_fma_f32 v[46:47], v[48:49], v[28:29], v[50:51] op_sel:[1,1,0] op_sel_hi:[0,1,1] neg_lo:[1,0,0]
  v_pk_mul_f32 v[50:51], v[46:47], v[28:29] op_sel_hi:[1,0]
  v_pk_fma_f32 v[48:49], v[46:47], v[28:29], v[50:51] op_sel:[1,1,0] op_sel_hi:[0,1,1] neg_lo:[1,0,0]
  v_cvt_pk_bf16_f32 v138, v46, v48
  v_cvt_pk_bf16_f32 v142, v47, v49
  v_pk_mul_f32 v[50:51], v[48:49], v[28:29] op_sel_hi:[1,0]
  v_pk_fma_f32 v[46:47], v[48:49], v[28:29], v[50:51] op_sel:[1,1,0] op_sel_hi:[0,1,1] neg_lo:[1,0,0]
  v_pk_mul_f32 v[50:51], v[46:47], v[28:29] op_sel_hi:[1,0]
  v_pk_fma_f32 v[48:49], v[46:47], v[28:29], v[50:51] op_sel:[1,1,0] op_sel_hi:[0,1,1] neg_lo:[1,0,0]
  v_cvt_pk_bf16_f32 v139, v46, v48
  v_cvt_pk_bf16_f32 v143, v47, v49
  v_pk_mul_f32 v[50:51], v[48:49], v[28:29] op_sel_hi:[1,0]
  v_pk_fma_f32 v[46:47], v[48:49], v[28:29], v[50:51] op_sel:[1,1,0] op_sel_hi:[0,1,1] neg_lo:[1,0,0]
  v_pk_mul_f32 v[50:51], v[46:47], v[28:29] op_sel_hi:[1,0]
  v_pk_fma_f32 v[48:49], v[46:47], v[28:29], v[50:51] op_sel:[1,1,0] op_sel_hi:[0,1,1] neg_lo:[1,0,0]
  v_cvt_pk_bf16_f32 v144, v46, v48
  v_cvt_pk_bf16_f32 v148, v47, v49
  v_pk_mul_f32 v[50:51], v[48:49], v[28:29] op_sel_hi:[1,0]
  v_pk_fma_f32 v[46:47], v[48:49], v[28:29], v[50:51] op_sel:[1,1,0] op_sel_hi:[0,1,1] neg_lo:[1,0,0]
  v_pk_mul_f32 v[50:51], v[46:47], v[28:29] op_sel_hi:[1,0]
  v_pk_fma_f32 v[48:49], v[46:47], v[28:29], v[50:51] op_sel:[1,1,0] op_sel_hi:[0,1,1] neg_lo:[1,0,0]
  v_cvt_pk_bf16_f32 v145, v46, v48
  v_cvt_pk_bf16_f32 v149, v47, v49
  v_pk_mul_f32 v[50:51], v[48:49], v[28:29] op_sel_hi:[1,0]
  v_pk_fma_f32 v[46:47], v[48:49], v[28:29], v[50:51] op_sel:[1,1,0] op_sel_hi:[0,1,1] neg_lo:[1,0,0]
  v_pk_mul_f32 v[50:51], v[46:47], v[28:29] op_sel_hi:[1,0]
  v_pk_fma_f32 v[48:49], v[46:47], v[28:29], v[50:51] op_sel:[1,1,0] op_sel_hi:[0,1,1] neg_lo:[1,0,0]
  v_cvt_pk_bf16_f32 v146, v46, v48
  v_cvt_pk_bf16_f32 v150, v47, v49
  v_pk_mul_f32 v[50:51], v[48:49], v[28:29] op_sel_hi:[1,0]
  v_pk_fma_f32 v[46:47], v[48:49], v[28:29], v[50:51] op_sel:[1,1,0] op_sel_hi:[0,1,1] neg_lo:[1,0,0]
  v_pk_mul_f32 v[50:51], v[46:47], v[28:29] op_sel_hi:[1,0]
  v_pk_fma_f32 v[48:49], v[46:47], v[28:29], v[50:51] op_sel:[1,1,0] op_sel_hi:[0,1,1] neg_lo:[1,0,0]
  v_cvt_pk_bf16_f32 v147, v46, v48
  v_cvt_pk_bf16_f32 v151, v47, v49
  v_and_b32 v20, 0xffff0000, v16
  v_and_b32 v21, 0xffff0000, v17
  v_and_b32 v34, 0xffff0000, v18
  v_and_b32 v35, 0xffff0000, v19
  v_mul_f32 v20, 0x3fb8aa3b, v20
  v_exp_f32 v20, v20
  v_mul_f32 v21, v21, v30
  v_cvt_pk_bf16_f32 v20, v20, v20
  v_and_b32 v20, 0xffff0000, v20
  v_mul_f32 v20, v20, v32
  v_mul_f32 v34, v34, v31
  v_mul_f32 v35, -v35, v31
  v_exp_f32 v22, v20
  v_fract_f32 v23, v21
  v_cos_f32 v24, v23
  v_sin_f32 v25, v23
  v_mul_f32 v24, v24, v22
  v_mul_f32 v25, v25, v22
  v_mul_f32 v22, 0x43800000, v20
  v_mul_f32 v23, 0x43800000, v21
  v_exp_f32 v22, v22
  v_fract_f32 v23, v23
  v_cos_f32 v26, v23
  v_sin_f32 v27, v23
  v_mul_f32 v26, v26, v22
  v_mul_f32 v27, v27, v22
  v_mul_f32 v22, 0x41000000, v20
  v_mul_f32 v23, 0x41000000, v21
  v_exp_f32 v22, v22
  v_fract_f32 v23, v23
  v_cos_f32 v28, v23
  v_sin_f32 v29, v23
  v_mul_f32 v28, v28, v22
  v_mul_f32 v29, v29, v22
  v_pk_mul_f32 v[52:53], v[34:35], v[24:25] op_sel_hi:[1,0]
  v_pk_fma_f32 v[42:43], v[34:35], v[24:25], v[52:53] op_sel:[1,1,0] op_sel_hi:[0,1,1] neg_hi:[1,0,0]
  v_cvt_pk_bf16_f32 v208, v34, v42
  v_cvt_pk_bf16_f32 v212, v35, v43
  v_pk_mul_f32 v[52:53], v[42:43], v[24:25] op_sel_hi:[1,0]
  v_pk_fma_f32 v[36:37], v[42:43], v[24:25], v[52:53] op_sel:[1,1,0] op_sel_hi:[0,1,1] neg_hi:[1,0,0]
  v_pk_mul_f32 v[52:53], v[36:37], v[24:25] op_sel_hi:[1,0]
  v_pk_fma_f32 v[42:43], v[36:37], v[24:25], v[52:53] op_sel:[1,1,0] op_sel_hi:[0,1,1] neg_hi:[1,0,0]
  v_cvt_pk_bf16_f32 v209, v36, v42
  v_cvt_pk_bf16_f32 v213, v37, v43
  v_pk_mul_f32 v[52:53], v[42:43], v[24:25] op_sel_hi:[1,0]
  v_pk_fma_f32 v[38:39], v[42:43], v[24:25], v[52:53] op_sel:[1,1,0] op_sel_hi:[0,1,1] neg_hi:[1,0,0]
  v_pk_mul_f32 v[52:53], v[38:39], v[24:25] op_sel_hi:[1,0]
  v_pk_fma_f32 v[42:43], v[38:39], v[24:25], v[52:53] op_sel:[1,1,0] op_sel_hi:[0,1,1] neg_hi:[1,0,0]
  v_cvt_pk_bf16_f32 v210, v38, v42
  v_cvt_pk_bf16_f32 v214, v39, v43
  v_pk_mul_f32 v[52:53], v[42:43], v[24:25] op_sel_hi:[1,0]
  v_pk_fma_f32 v[40:41], v[42:43], v[24:25], v[52:53] op_sel:[1,1,0] op_sel_hi:[0,1,1] neg_hi:[1,0,0]
  v_pk_mul_f32 v[52:53], v[40:41], v[24:25] op_sel_hi:[1,0]
  v_pk_fma_f32 v[42:43], v[40:41], v[24:25], v[52:53] op_sel:[1,1,0] op_sel_hi:[0,1,1] neg_hi:[1,0,0]
  v_cvt_pk_bf16_f32 v211, v40, v42
  v_cvt_pk_bf16_f32 v215, v41, v43
  v_pk_mul_f32 v[52:53], v[34:35], v[26:27] op_sel_hi:[1,0]
  v_pk_fma_f32 v[34:35], v[34:35], v[26:27], v[52:53] op_sel:[1,1,0] op_sel_hi:[0,1,1] neg_hi:[1,0,0]
  v_pk_mul_f32 v[52:53], v[36:37], v[26:27] op_sel_hi:[1,0]
  v_pk_fma_f32 v[36:37], v[36:37], v[26:27], v[52:53] op_sel:[1,1,0] op_sel_hi:[0,1,1] neg_hi:[1,0,0]
  v_cvt_pk_bf16_f32 v216, v34, v36
  v_cvt_pk_bf16_f32 v220, v35, v37
  v_pk_mul_f32 v[52:53], v[38:39], v[26:27] op_sel_hi:[1,0]
  v_pk_fma_f32 v[38:39], v[38:39], v[26:27], v[52:53] op_sel:[1,1,0] op_sel_hi:[0,1,1] neg_hi:[1,0,0]
  v_pk_mul_f32 v[52:53], v[40:41], v[26:27] op_sel_hi:[1,0]
  v_pk_fma_f32 v[40:41], v[40:41], v[26:27], v[52:53] op_sel:[1,1,0] op_sel_hi:[0,1,1] neg_hi:[1,0,0]
  v_cvt_pk_bf16_f32 v217, v38, v40
  v_cvt_pk_bf16_f32 v221, v39, v41
  v_pk_mul_f32 v[52:53], v[34:35], v[26:27] op_sel_hi:[1,0]
  v_pk_fma_f32 v[34:35], v[34:35], v[26:27], v[52:53] op_sel:[1,1,0] op_sel_hi:[0,1,1] neg_hi:[1,0,0]
  v_pk_mul_f32 v[52:53], v[38:39], v[26:27] op_sel_hi:[1,0]
  v_pk_fma_f32 v[38:39], v[38:39], v[26:27], v[52:53] op_sel:[1,1,0] op_sel_hi:[0,1,1] neg_hi:[1,0,0]
  v_cvt_pk_bf16_f32 v218, v34, v38
  v_cvt_pk_bf16_f32 v222, v35, v39
  v_pk_mul_f32 v[52:53], v[34:35], v[26:27] op_sel_hi:[1,0]
  v_pk_fma_f32 v[34:35], v[34:35], v[26:27], v[52:53] op_sel:[1,1,0] op_sel_hi:[0,1,1] neg_hi:[1,0,0]
  v_pk_mul_f32 v[52:53], v[38:39], v[26:27] op_sel_hi:[1,0]
  v_pk_fma_f32 v[38:39], v[38:39], v[26:27], v[52:53] op_sel:[1,1,0] op_sel_hi:[0,1,1] neg_hi:[1,0,0]
  v_cvt_pk_bf16_f32 v219, v34, v38
  v_cvt_pk_bf16_f32 v223, v35, v39
  v_pk_mul_f32 v[52:53], v[34:35], v[26:27] op_sel_hi:[1,0]
  v_pk_fma_f32 v[42:43], v[34:35], v[26:27], v[52:53] op_sel:[1,1,0] op_sel_hi:[0,1,1] neg_hi:[1,0,0]
  v_pk_mul_f32 v[52:53], v[42:43], v[26:27] op_sel_hi:[1,0]
  v_pk_fma_f32 v[44:45], v[42:43], v[26:27], v[52:53] op_sel:[1,1,0] op_sel_hi:[0,1,1] neg_hi:[1,0,0]
  v_cvt_pk_bf16_f32 v224, v42, v44
  v_cvt_pk_bf16_f32 v228, v43, v45
  v_pk_mul_f32 v[52:53], v[44:45], v[26:27] op_sel_hi:[1,0]
  v_pk_fma_f32 v[42:43], v[44:45], v[26:27], v[52:53] op_sel:[1,1,0] op_sel_hi:[0,1,1] neg_hi:[1,0,0]
  v_pk_mul_f32 v[52:53], v[42:43], v[26:27] op_sel_hi:[1,0]
  v_pk_fma_f32 v[44:45], v[42:43], v[26:27], v[52:53] op_sel:[1,1,0] op_sel_hi:[0,1,1] neg_hi:[1,0,0]
  v_cvt_pk_bf16_f32 v225, v42, v44
  v_cvt_pk_bf16_f32 v229, v43, v45
  v_pk_mul_f32 v[52:53], v[44:45], v[26:27] op_sel_hi:[1,0]
  v_pk_fma_f32 v[42:43], v[44:45], v[26:27], v[52:53] op_sel:[1,1,0] op_sel_hi:[0,1,1] neg_hi:[1,0,0]
  v_cvt_pk_bf16_f32 v226, v42, v42
  v_cvt_pk_bf16_f32 v230, v43, v43
  v_mov_b32 v227, 0
  v_mov_b32 v231, 0
  v_cvt_pk_bf16_f32 v176, 1.0, v28
  v_cvt_pk_bf16_f32 v180, 0, v29
  v_pk_mul_f32 v[50:51], v[28:29], v[28:29] op_sel_hi:[1,0]
  v_pk_fma_f32 v[46:47], v[28:29], v[28:29], v[50:51] op_sel:[1,1,0] op_sel_hi:[0,1,1] neg_lo:[1,0,0]
  v_pk_mul_f32 v[50:51], v[46:47], v[28:29] op_sel_hi:[1,0]
  v_pk_fma_f32 v[48:49], v[46:47], v[28:29], v[50:51] op_sel:[1,1,0] op_sel_hi:[0,1,1] neg_lo:[1,0,0]
  v_cvt_pk_bf16_f32 v177, v46, v48
  v_cvt_pk_bf16_f32 v181, v47, v49
  v_pk_mul_f32 v[50:51], v[48:49], v[28:29] op_sel_hi:[1,0]
  v_pk_fma_f32 v[46:47], v[48:49], v[28:29], v[50:51] op_sel:[1,1,0] op_sel_hi:[0,1,1] neg_lo:[1,0,0]
  v_pk_mul_f32 v[50:51], v[46:47], v[28:29] op_sel_hi:[1,0]
  v_pk_fma_f32 v[48:49], v[46:47], v[28:29], v[50:51] op_sel:[1,1,0] op_sel_hi:[0,1,1] neg_lo:[1,0,0]
  v_cvt_pk_bf16_f32 v178, v46, v48
  v_cvt_pk_bf16_f32 v182, v47, v49
  v_pk_mul_f32 v[50:51], v[48:49], v[28:29] op_sel_hi:[1,0]
  v_pk_fma_f32 v[46:47], v[48:49], v[28:29], v[50:51] op_sel:[1,1,0] op_sel_hi:[0,1,1] neg_lo:[1,0,0]
  v_pk_mul_f32 v[50:51], v[46:47], v[28:29] op_sel_hi:[1,0]
  v_pk_fma_f32 v[48:49], v[46:47], v[28:29], v[50:51] op_sel:[1,1,0] op_sel_hi:[0,1,1] neg_lo:[1,0,0]
  v_cvt_pk_bf16_f32 v179, v46, v48
  v_cvt_pk_bf16_f32 v183, v47, v49
  v_pk_mul_f32 v[50:51], v[48:49], v[28:29] op_sel_hi:[1,0]
  v_pk_fma_f32 v[46:47], v[48:49], v[28:29], v[50:51] op_sel:[1,1,0] op_sel_hi:[0,1,1] neg_lo:[1,0,0]
  v_pk_mul_f32 v[50:51], v[46:47], v[28:29] op_sel_hi:[1,0]
  v_pk_fma_f32 v[48:49], v[46:47], v[28:29], v[50:51] op_sel:[1,1,0] op_sel_hi:[0,1,1] neg_lo:[1,0,0]
  v_cvt_pk_bf16_f32 v184, v46, v48
  v_cvt_pk_bf16_f32 v188, v47, v49
  v_pk_mul_f32 v[50:51], v[48:49], v[28:29] op_sel_hi:[1,0]
  v_pk_fma_f32 v[46:47], v[48:49], v[28:29], v[50:51] op_sel:[1,1,0] op_sel_hi:[0,1,1] neg_lo:[1,0,0]
  v_pk_mul_f32 v[50:51], v[46:47], v[28:29] op_sel_hi:[1,0]
  v_pk_fma_f32 v[48:49], v[46:47], v[28:29], v[50:51] op_sel:[1,1,0] op_sel_hi:[0,1,1] neg_lo:[1,0,0]
  v_cvt_pk_bf16_f32 v185, v46, v48
  v_cvt_pk_bf16_f32 v189, v47, v49
  v_pk_mul_f32 v[50:51], v[48:49], v[28:29] op_sel_hi:[1,0]
  v_pk_fma_f32 v[46:47], v[48:49], v[28:29], v[50:51] op_sel:[1,1,0] op_sel_hi:[0,1,1] neg_lo:[1,0,0]
  v_pk_mul_f32 v[50:51], v[46:47], v[28:29] op_sel_hi:[1,0]
  v_pk_fma_f32 v[48:49], v[46:47], v[28:29], v[50:51] op_sel:[1,1,0] op_sel_hi:[0,1,1] neg_lo:[1,0,0]
  v_cvt_pk_bf16_f32 v186, v46, v48
  v_cvt_pk_bf16_f32 v190, v47, v49
  v_pk_mul_f32 v[50:51], v[48:49], v[28:29] op_sel_hi:[1,0]
  v_pk_fma_f32 v[46:47], v[48:49], v[28:29], v[50:51] op_sel:[1,1,0] op_sel_hi:[0,1,1] neg_lo:[1,0,0]
  v_pk_mul_f32 v[50:51], v[46:47], v[28:29] op_sel_hi:[1,0]
  v_pk_fma_f32 v[48:49], v[46:47], v[28:29], v[50:51] op_sel:[1,1,0] op_sel_hi:[0,1,1] neg_lo:[1,0,0]
  v_cvt_pk_bf16_f32 v187, v46, v48
  v_cvt_pk_bf16_f32 v191, v47, v49
  v_pk_mul_f32 v[50:51], v[48:49], v[28:29] op_sel_hi:[1,0]
  v_pk_fma_f32 v[46:47], v[48:49], v[28:29], v[50:51] op_sel:[1,1,0] op_sel_hi:[0,1,1] neg_lo:[1,0,0]
  v_pk_mul_f32 v[50:51], v[46:47], v[28:29] op_sel_hi:[1,0]
  v_pk_fma_f32 v[48:49], v[46:47], v[28:29], v[50:51] op_sel:[1,1,0] op_sel_hi:[0,1,1] neg_lo:[1,0,0]
  v_cvt_pk_bf16_f32 v192, v46, v48
  v_cvt_pk_bf16_f32 v196, v47, v49
  v_pk_mul_f32 v[50:51], v[48:49], v[28:29] op_sel_hi:[1,0]
  v_pk_fma_f32 v[46:47], v[48:49], v[28:29], v[50:51] op_sel:[1,1,0] op_sel_hi:[0,1,1] neg_lo:[1,0,0]
  v_pk_mul_f32 v[50:51], v[46:47], v[28:29] op_sel_hi:[1,0]
  v_pk_fma_f32 v[48:49], v[46:47], v[28:29], v[50:51] op_sel:[1,1,0] op_sel_hi:[0,1,1] neg_lo:[1,0,0]
  v_cvt_pk_bf16_f32 v193, v46, v48
  v_cvt_pk_bf16_f32 v197, v47, v49
  v_pk_mul_f32 v[50:51], v[48:49], v[28:29] op_sel_hi:[1,0]
  v_pk_fma_f32 v[46:47], v[48:49], v[28:29], v[50:51] op_sel:[1,1,0] op_sel_hi:[0,1,1] neg_lo:[1,0,0]
  v_pk_mul_f32 v[50:51], v[46:47], v[28:29] op_sel_hi:[1,0]
  v_pk_fma_f32 v[48:49], v[46:47], v[28:29], v[50:51] op_sel:[1,1,0] op_sel_hi:[0,1,1] neg_lo:[1,0,0]
  v_cvt_pk_bf16_f32 v194, v46, v48
  v_cvt_pk_bf16_f32 v198, v47, v49
  v_pk_mul_f32 v[50:51], v[48:49], v[28:29] op_sel_hi:[1,0]
  v_pk_fma_f32 v[46:47], v[48:49], v[28:29], v[50:51] op_sel:[1,1,0] op_sel_hi:[0,1,1] neg_lo:[1,0,0]
  v_pk_mul_f32 v[50:51], v[46:47], v[28:29] op_sel_hi:[1,0]
  v_pk_fma_f32 v[48:49], v[46:47], v[28:29], v[50:51] op_sel:[1,1,0] op_sel_hi:[0,1,1] neg_lo:[1,0,0]
  v_cvt_pk_bf16_f32 v195, v46, v48
  v_cvt_pk_bf16_f32 v199, v47, v49
  v_pk_mul_f32 v[50:51], v[48:49], v[28:29] op_sel_hi:[1,0]
  v_pk_fma_f32 v[46:47], v[48:49], v[28:29], v[50:51] op_sel:[1,1,0] op_sel_hi:[0,1,1] neg_lo:[1,0,0]
  v_pk_mul_f32 v[50:51], v[46:47], v[28:29] op_sel_hi:[1,0]
  v_pk_fma_f32 v[48:49], v[46:47], v[28:29], v[50:51] op_sel:[1,1,0] op_sel_hi:[0,1,1] neg_lo:[1,0,0]
  v_cvt_pk_bf16_f32 v200, v46, v48
  v_cvt_pk_bf16_f32 v204, v47, v49
  v_pk_mul_f32 v[50:51], v[48:49], v[28:29] op_sel_hi:[1,0]
  v_pk_fma_f32 v[46:47], v[48:49], v[28:29], v[50:51] op_sel:[1,1,0] op_sel_hi:[0,1,1] neg_lo:[1,0,0]
  v_pk_mul_f32 v[50:51], v[46:47], v[28:29] op_sel_hi:[1,0]
  v_pk_fma_f32 v[48:49], v[46:47], v[28:29], v[50:51] op_sel:[1,1,0] op_sel_hi:[0,1,1] neg_lo:[1,0,0]
  v_cvt_pk_bf16_f32 v201, v46, v48
  v_cvt_pk_bf16_f32 v205, v47, v49
  v_pk_mul_f32 v[50:51], v[48:49], v[28:29] op_sel_hi:[1,0]
  v_pk_fma_f32 v[46:47], v[48:49], v[28:29], v[50:51] op_sel:[1,1,0] op_sel_hi:[0,1,1] neg_lo:[1,0,0]
  v_pk_mul_f32 v[50:51], v[46:47], v[28:29] op_sel_hi:[1,0]
  v_pk_fma_f32 v[48:49], v[46:47], v[28:29], v[50:51] op_sel:[1,1,0] op_sel_hi:[0,1,1] neg_lo:[1,0,0]
  v_cvt_pk_bf16_f32 v202, v46, v48
  v_cvt_pk_bf16_f32 v206, v47, v49
  v_pk_mul_f32 v[50:51], v[48:49], v[28:29] op_sel_hi:[1,0]
  v_pk_fma_f32 v[46:47], v[48:49], v[28:29], v[50:51] op_sel:[1,1,0] op_sel_hi:[0,1,1] neg_lo:[1,0,0]
  v_pk_mul_f32 v[50:51], v[46:47], v[28:29] op_sel_hi:[1,0]
  v_pk_fma_f32 v[48:49], v[46:47], v[28:29], v[50:51] op_sel:[1,1,0] op_sel_hi:[0,1,1] neg_lo:[1,0,0]
  v_cvt_pk_bf16_f32 v203, v46, v48
  v_cvt_pk_bf16_f32 v207, v47, v49
  s_cmp_lt_u32 s4, 4
  s_cbranch_scc1 L_pr_7
  s_lshl_b32 s8, s2, 8
  s_add_u32 s8, s8, 327680
  s_mov_b32 s40, s46
  s_mov_b32 s41, s46
  s_mov_b32 s47, 1048576
L_sp_18:
  s_load_dword s16, s[44:45], s8 glc
  s_waitcnt lgkmcnt(0)
  s_cmp_eq_u32 s16, s46
  s_cbranch_scc1 L_spd_20
L_spr_19:
  s_sleep 1
  s_sub_u32 s47, s47, 1
  s_cmp_gt_i32 s47, 0
  s_cbranch_scc1 L_sp_18
L_spd_20:
  s_mul_i32 s12, s10, 384
  s_mul_i32 s13, s10, 6144
  s_lshl_b32 s8, s9, 10
  s_add_u32 s13, s13, s8
  s_add_u32 m0, s13, 0
  s_nop 0
  buffer_load_dwordx4 v5, s[48:51], s12 offen lds
  s_add_u32 s12, s12, 128
  s_add_u32 m0, s13, 2048
  s_nop 0
  buffer_load_dwordx4 v5, s[48:51], s12 offen lds
  s_add_u32 s12, s12, 128
  s_add_u32 m0, s13, 4096
  s_nop 0
  buffer_load_dwordx4 v5, s[48:51], s12 offen lds
  s_add_u32 s12, s12, 128
  s_add_u32 m0, s13, 6144
  s_nop 0
  buffer_load_dwordx4 v5, s[48:51], s12 offen lds
  s_add_u32 m0, s15, s70
  s_nop 0
  buffer_load_dwordx4 v6, s[52:55], s70 offen lds
  s_add_u32 s70, s70, 4096
  s_cmp_eq_u32 s70, 28672
  s_cselect_b32 s70, 0, s70
  s_add_u32 m0, s15, s70
  s_nop 0
  buffer_load_dwordx4 v6, s[52:55], s70 offen lds
  s_add_u32 s70, s70, 4096
  s_cmp_eq_u32 s70, 28672
  s_cselect_b32 s70, 0, s70
  s_add_u32 m0, s15, s70
  s_nop 0
  buffer_load_dwordx4 v6, s[52:55], s70 offen lds
  s_add_u32 s70, s70, 4096
  s_cmp_eq_u32 s70, 28672
  s_cselect_b32 s70, 0, s70
  s_add_u32 m0, s15, s70
  s_nop 0
  buffer_load_dwordx4 v6, s[52:55], s70 offen lds
  s_add_u32 s70, s70, 4096
  s_cmp_eq_u32 s70, 28672
  s_cselect_b32 s70, 0, s70
  s_add_u32 m0, s15, s70
  s_nop 0
  buffer_load_dwordx4 v6, s[52:55], s70 offen lds
  s_add_u32 s70, s70, 4096
  s_cmp_eq_u32 s70, 28672
  s_cselect_b32 s70, 0, s70
  s_add_u32 m0, s15, s70
  s_nop 0
  buffer_load_dwordx4 v6, s[52:55], s70 offen lds
  s_add_u32 s70, s70, 4096
  s_cmp_eq_u32 s70, 28672
  s_cselect_b32 s70, 0, s70
  s_add_u32 m0, s15, s70
  s_nop 0
  buffer_load_dwordx4 v6, s[52:55], s70 offen lds
  s_waitcnt vmcnt(0)
  s_barrier
  s_cmp_ge_u32 s3, 2
  s_cbranch_scc1 L_kvb_21
  ds_read_b128 v[56:59], v10 offset:0
  ds_read_b64_tr_b16 v[60:61], v12 offset:0
  ds_read_b64_tr_b16 v[62:63], v12 offset:224
  ds_read_b128 v[64:67], v11 offset:0
  ds_read_b64_tr_b16 v[68:69], v12 offset:1792
  ds_read_b64_tr_b16 v[70:71], v12 offset:2016
  ds_read_b128 v[72:75], v10 offset:2048
  ds_read_b64_tr_b16 v[76:77], v12 offset:3584
  ds_read_b64_tr_b16 v[78:79], v12 offset:3808
  ds_read_b128 v[80:83], v11 offset:2048
  ds_read_b64_tr_b16 v[84:85], v12 offset:5376
  ds_read_b64_tr_b16 v[86:87], v12 offset:5600
  s_bitcmp1_b32 s6, 0
  s_cbranch_scc1 L_kvV_23
  ds_read_b128 v[88:91], v10 offset:4096
  ds_read_b64_tr_b16 v[92:93], v12 offset:7168
  ds_read_b64_tr_b16 v[94:95], v12 offset:7392
  s_waitcnt lgkmcnt(12)
  v_mfma_f32_16x16x32_bf16 v[100:103], v[60:63], v[56:59], 0
  ds_read_b128 v[56:59], v11 offset:4096
  ds_read_b64_tr_b16 v[60:61], v12 offset:8960
  ds_read_b64_tr_b16 v[62:63], v12 offset:9184
  s_waitcnt lgkmcnt(12)
  v_mfma_f32_16x16x32_bf16 v[100:103], v[68:71], v[64:67], v[100:103]
  ds_read_b128 v[64:67], v10 offset:6144
  ds_read_b64_tr_b16 v[68:69], v12 offset:10752
  ds_read_b64_tr_b16 v[70:71], v12 offset:10976
  s_waitcnt lgkmcnt(12)
  v_mfma_f32_16x16x32_bf16 v[100:103], v[76:79], v[72:75], v[100:103]
  ds_read_b128 v[72:75], v11 offset:6144
  ds_read_b64_tr_b16 v[76:77], v12 offset:12544
  ds_read_b64_tr_b16 v[78:79], v12 offset:12768
  s_waitcnt lgkmcnt(12)
  v_mfma_f32_16x16x32_bf16 v[100:103], v[84:87], v[80:83], v[100:103]
  ds_read_b128 v[80:83], v10 offset:8192
  ds_read_b64_tr_b16 v[84:85], v12 offset:14336
  ds_read_b64_tr_b16 v[86:87], v12 offset:14560
  s_waitcnt lgkmcnt(12)
  v_mfma_f32_16x16x32_bf16 v[100:103], v[92:95], v[88:91], v[100:103]
  ds_read_b128 v[88:91], v11 offset:8192
  ds_read_b64_tr_b16 v[92:93], v12 offset:16128
  ds_read_b64_tr_b16 v[94:95], v12 offset:16352
  s_waitcnt lgkmcnt(12)
  v_mfma_f32_16x16x32_bf16 v[100:103], v[60:63], v[56:59], v[100:103]
  ds_read_b128 v[56:59], v10 offset:10240
  ds_read_b64_tr_b16 v[60:61], v12 offset:17920
  ds_read_b64_tr_b16 v[62:63], v12 offset:18144
  s_waitcnt lgkmcnt(12)
  v_mfma_f32_16x16x32_bf16 v[100:103], v[68:71], v[64:67], v[100:103]
  ds_read_b128 v[64:67], v11 offset:10240
  ds_read_b64_tr_b16 v[68:69], v12 offset:19712
  ds_read_b64_tr_b16 v[70:71], v12 offset:19936
  s_waitcnt lgkmcnt(12)
  v_mfma_f32_16x16x32_bf16 v[100:103], v[76:79], v[72:75], v[100:103]
  ds_read_b128 v[72:75], v10 offset:12288
  ds_read_b64_tr_b16 v[76:77], v12 offset:21504
  ds_read_b64_tr_b16 v[78:79], v12 offset:21728
  s_waitcnt lgkmcnt(12)
  v_mfma_f32_16x16x32_bf16 v[100:103], v[84:87], v[80:83], v[100:103]
  ds_read_b128 v[80:83], v11 offset:12288
  ds_read_b64_tr_b16 v[84:85], v12 offset:23296
  ds_read_b64_tr_b16 v[86:87], v12 offset:23520
  s_waitcnt lgkmcnt(12)
  v_mfma_f32_16x16x32_bf16 v[100:103], v[92:95], v[88:91], v[100:103]
  s_waitcnt lgkmcnt(9)
  v_mfma_f32_16x16x32_bf16 v[100:103], v[60:63], v[56:59], v[100:103]
  s_waitcnt lgkmcnt(6)
  v_mfma_f32_16x16x32_bf16 v[100:103], v[68:71], v[64:67], v[100:103]
  s_waitcnt lgkmcnt(3)
  v_mfma_f32_16x16x32_bf16 v[100:103], v[76:79], v[72:75], v[100:103]
  s_waitcnt lgkmcnt(0)
  v_mfma_f32_16x16x32_bf16 v[100:103], v[84:87], v[80:83], v[100:103]
  s_cmp_eq_u32 s3, 1
  s_cselect_b32 s12, 0xffff0000, 0
  s_nop 5
  v_mul_f32 v100, 0x3e8b97f6, v100
  v_mul_f32 v101, 0x3e8b97f6, v101
  v_mul_f32 v102, 0x3e8b97f6, v102
  v_mul_f32 v103, 0x3e8b97f6, v103
  v_cvt_pk_bf16_f32 v96, v100, v101
  v_cvt_pk_bf16_f32 v97, v102, v103
  s_mov_b32 exec_lo, 0
  s_mov_b32 exec_hi, s12
  v_mov_b32 v96, 0x3f803f80
  v_mov_b32 v97, 0x00003f80
  s_mov_b64 exec, -1
  s_branch L_kvst_24
L_kvV_23:
  ds_read_b128 v[88:91], v10 offset:4096
  ds_read_b64_tr_b16 v[92:93], v12 offset:7168
  ds_read_b64_tr_b16 v[94:95], v12 offset:7392
  s_waitcnt lgkmcnt(12)
  v_mfma_f32_16x16x32_bf16 v[100:103], v[56:59], v[60:63], 0
  ds_read_b128 v[56:59], v11 offset:4096
  ds_read_b64_tr_b16 v[60:61], v12 offset:8960
  ds_read_b64_tr_b16 v[62:63], v12 offset:9184
  s_waitcnt lgkmcnt(12)
  v_mfma_f32_16x16x32_bf16 v[100:103], v[64:67], v[68:71], v[100:103]
  ds_read_b128 v[64:67], v10 offset:6144
  ds_read_b64_tr_b16 v[68:69], v12 offset:10752
  ds_read_b64_tr_b16 v[70:71], v12 offset:10976
  s_waitcnt lgkmcnt(12)
  v_mfma_f32_16x16x32_bf16 v[100:103], v[72:75], v[76:79], v[100:103]
  ds_read_b128 v[72:75], v11 offset:6144
  ds_read_b64_tr_b16 v[76:77], v12 offset:12544
  ds_read_b64_tr_b16 v[78:79], v12 offset:12768
  s_waitcnt lgkmcnt(12)
  v_mfma_f32_16x16x32_bf16 v[100:103], v[80:83], v[84:87], v[100:103]
  ds_read_b128 v[80:83], v10 offset:8192
  ds_read_b64_tr_b16 v[84:85], v12 offset:14336
  ds_read_b64_tr_b16 v[86:87], v12 offset:14560
  s_waitcnt lgkmcnt(12)
  v_mfma_f32_16x16x32_bf16 v[100:103], v[88:91], v[92:95], v[100:103]
  ds_read_b128 v[88:91], v11 offset:8192
  ds_read_b64_tr_b16 v[92:93], v12 offset:16128
  ds_read_b64_tr_b16 v[94:95], v12 offset:16352
  s_waitcnt lgkmcnt(12)
  v_mfma_f32_16x16x32_bf16 v[100:103], v[56:59], v[60:63], v[100:103]
  ds_read_b128 v[56:59], v10 offset:10240
  ds_read_b64_tr_b16 v[60:61], v12 offset:17920
  ds_read_b64_tr_b16 v[62:63], v12 offset:18144
  s_waitcnt lgkmcnt(12)
  v_mfma_f32_16x16x32_bf16 v[100:103], v[64:67], v[68:71], v[100:103]
  ds_read_b128 v[64:67], v11 offset:10240
  ds_read_b64_tr_b16 v[68:69], v12 offset:19712
  ds_read_b64_tr_b16 v[70:71], v12 offset:19936
  s_waitcnt lgkmcnt(12)
  v_mfma_f32_16x16x32_bf16 v[100:103], v[72:75], v[76:79], v[100:103]
  ds_read_b128 v[72:75], v10 offset:12288
  ds_read_b64_tr_b16 v[76:77], v12 offset:21504
  ds_read_b64_tr_b16 v[78:79], v12 offset:21728
  s_waitcnt lgkmcnt(12)
  v_mfma_f32_16x16x32_bf16 v[100:103], v[80:83], v[84:87], v[100:103]
  ds_read_b128 v[80:83], v11 offset:12288
  ds_read_b64_tr_b16 v[84:85], v12 offset:23296
  ds_read_b64_tr_b16 v[86:87], v12 offset:23520
  s_waitcnt lgkmcnt(12)
  v_mfma_f32_16x16x32_bf16 v[100:103], v[88:91], v[92:95], v[100:103]
  s_waitcnt lgkmcnt(9)
  v_mfma_f32_16x16x32_bf16 v[100:103], v[56:59], v[60:63], v[100:103]
  s_waitcnt lgkmcnt(6)
  v_mfma_f32_16x16x32_bf16 v[100:103], v[64:67], v[68:71], v[100:103]
  s_waitcnt lgkmcnt(3)
  v_mfma_f32_16x16x32_bf16 v[100:103], v[72:75], v[76:79], v[100:103]
  s_waitcnt lgkmcnt(0)
  v_mfma_f32_16x16x32_bf16 v[100:103], v[80:83], v[84:87], v[100:103]
  s_cmp_eq_u32 s3, 1
  s_cselect_b32 s12, 0xe000e000, 0
  s_cselect_b32 s13, 0x10001000, 0
  s_nop 4
  v_cvt_pk_bf16_f32 v96, v100, v101
  v_cvt_pk_bf16_f32 v97, v102, v103
  s_mov_b32 exec_lo, s12
  s_mov_b32 exec_hi, s12
  v_mov_b32 v96, 0
  v_mov_b32 v97, 0
  s_mov_b32 exec_lo, s13
  s_mov_b32 exec_hi, s13
  v_mov_b32 v96, 0x3f803f80
  v_mov_b32 v97, 0x3f803f80
  s_mov_b64 exec, -1
L_kvst_24:
  s_nop 1
  v_permlane32_swap_b32 v96, v98
  v_permlane32_swap_b32 v97, v99
  s_mov_b32 exec_hi, 0
  buffer_store_dwordx4 v[96:99], v13, s[56:59], s69 offen sc1
  s_mov_b32 exec_hi, -1
L_kvb_21:
  v_mov_b32 v33, s46
  s_waitcnt vmcnt(0)
  s_barrier
  s_cmp_lg_u32 s3, 0
  s_cbranch_scc1 L_kvf_22
  s_mov_b64 exec, 0xffffffff
  buffer_store_dword v33, v14, s[56:59], s68 offen sc1
  s_mov_b64 exec, -1
L_kvf_22:
L_pr_7:
  ds_write_b128 v2, v[120:123] offset:0
  ds_write_b128 v2, v[124:127] offset:64
  ds_write_b128 v2, v[128:131] offset:16
  ds_write_b128 v2, v[132:135] offset:80
  ds_write_b128 v2, v[136:139] offset:32
  ds_write_b128 v2, v[140:143] offset:96
  ds_write_b128 v2, v[144:147] offset:48
  ds_write_b128 v2, v[148:151] offset:112
  ds_write_b128 v2, v[152:155] offset:128
  ds_write_b128 v2, v[156:159] offset:176
  ds_write_b128 v2, v[160:163] offset:144
  ds_write_b128 v2, v[164:167] offset:192
  ds_write_b128 v2, v[168:171] offset:160
  ds_write_b128 v2, v[172:175] offset:208
  s_mul_i32 s8, s10, 30720
  s_waitcnt vmcnt(0) lgkmcnt(0)
  ds_read_b64_tr_b16 v[56:57], v3 offset:0
  ds_read_b64_tr_b16 v[58:59], v3 offset:240
  ds_read_b64_tr_b16 v[60:61], v3 offset:128
  ds_read_b64_tr_b16 v[62:63], v3 offset:368
  ds_read_b64_tr_b16 v[64:65], v3 offset:64
  ds_read_b64_tr_b16 v[66:67], v3 offset:304
  ds_read_b64_tr_b16 v[68:69], v3 offset:176
  ds_read_b64_tr_b16 v[70:71], v3 offset:416
  ds_read_b64_tr_b16 v[72:73], v3 offset:3840
  ds_read_b64_tr_b16 v[74:75], v3 offset:4080
  ds_read_b64_tr_b16 v[76:77], v3 offset:3968
  ds_read_b64_tr_b16 v[78:79], v3 offset:4208
  ds_read_b64_tr_b16 v[80:81], v3 offset:3904
  ds_read_b64_tr_b16 v[82:83], v3 offset:4144
  ds_read_b64_tr_b16 v[84:85], v3 offset:4016
  ds_read_b64_tr_b16 v[86:87], v3 offset:4256
  ds_read_b64_tr_b16 v[88:89], v3 offset:7680
  ds_read_b64_tr_b16 v[90:91], v3 offset:7920
  ds_read_b64_tr_b16 v[92:93], v3 offset:7808
  ds_read_b64_tr_b16 v[94:95], v3 offset:8048
  ds_read_b64_tr_b16 v[96:97], v3 offset:7744
  ds_read_b64_tr_b16 v[98:99], v3 offset:7984
  ds_read_b64_tr_b16 v[100:101], v3 offset:7856
  ds_read_b64_tr_b16 v[102:103], v3 offset:8096
  v_add_u32 v120, s8, v104
  v_add_u32 v121, s8, v105
  v_add_u32 v122, s8, v106
  v_add_u32 v123, s8, v107
  v_add_u32 v124, s8, v108
  v_add_u32 v125, s8, v109
  v_add_u32 v126, s8, v110
  v_add_u32 v127, s8, v111
  v_add_u32 v128, s8, v112
  v_add_u32 v129, s8, v113
  v_add_u32 v130, s8, v114
  v_add_u32 v131, s8, v115
  v_add_u32 v132, s8, v116
  v_add_u32 v133, s8, v117
  v_add_u32 v134, s8, v118
  v_add_u32 v135, s8, v119
  ds_read_b64_tr_b16 v[104:105], v3 offset:11520
  ds_read_b64_tr_b16 v[106:107], v3 offset:11760
  ds_read_b64_tr_b16 v[108:109], v3 offset:11648
  ds_read_b64_tr_b16 v[110:111], v3 offset:11888
  ds_read_b64_tr_b16 v[112:113], v3 offset:11584
  ds_read_b64_tr_b16 v[114:115], v3 offset:11824
  ds_read_b64_tr_b16 v[116:117], v3 offset:11696
  ds_read_b64_tr_b16 v[118:119], v3 offset:11936
  s_setprio 0
  s_waitcnt lgkmcnt(0)
  v_mfma_f32_32x32x16_bf16 v[40:55], v[56:59], v[60:63], 0
  ds_write_b128 v2, v[176:179] offset:0
  ds_write_b128 v2, v[180:183] offset:64
  v_mfma_f32_32x32x16_bf16 v[40:55], v[64:67], v[68:71], v[40:55]
  ds_write_b128 v2, v[184:187] offset:16
  ds_write_b128 v2, v[188:191] offset:80
  v_mfma_f32_32x32x16_bf16 v[40:55], v[72:75], v[76:79], v[40:55]
  ds_write_b128 v2, v[192:195] offset:32
  ds_write_b128 v2, v[196:199] offset:96
  v_mfma_f32_32x32x16_bf16 v[40:55], v[80:83], v[84:87], v[40:55]
  ds_write_b128 v2, v[200:203] offset:48
  ds_write_b128 v2, v[204:207] offset:112
  v_mfma_f32_32x32x16_bf16 v[40:55], v[88:91], v[92:95], v[40:55]
  ds_write_b128 v2, v[208:211] offset:128
  ds_write_b128 v2, v[212:215] offset:176
  v_mfma_f32_32x32x16_bf16 v[40:55], v[96:99], v[100:103], v[40:55]
  ds_write_b128 v2, v[216:219] offset:144
  ds_write_b128 v2, v[220:223] offset:192
  v_mfma_f32_32x32x16_bf16 v[40:55], v[104:107], v[108:111], v[40:55]
  ds_write_b128 v2, v[224:227] offset:160
  ds_write_b128 v2, v[228:231] offset:208
  v_mfma_f32_32x32x16_bf16 v[40:55], v[112:115], v[116:119], v[40:55]
  s_waitcnt lgkmcnt(0)
  ds_read_b64_tr_b16 v[56:57], v3 offset:0
  ds_read_b64_tr_b16 v[58:59], v3 offset:240
  ds_read_b64_tr_b16 v[60:61], v3 offset:128
  ds_read_b64_tr_b16 v[62:63], v3 offset:368
  ds_read_b64_tr_b16 v[64:65], v3 offset:64
  ds_read_b64_tr_b16 v[66:67], v3 offset:304
  ds_read_b64_tr_b16 v[68:69], v3 offset:176
  ds_read_b64_tr_b16 v[70:71], v3 offset:416
  ds_read_b64_tr_b16 v[72:73], v3 offset:3840
  ds_read_b64_tr_b16 v[74:75], v3 offset:4080
  ds_read_b64_tr_b16 v[76:77], v3 offset:3968
  ds_read_b64_tr_b16 v[78:79], v3 offset:4208
  ds_read_b64_tr_b16 v[80:81], v3 offset:3904
  ds_read_b64_tr_b16 v[82:83], v3 offset:4144
  ds_read_b64_tr_b16 v[84:85], v3 offset:4016
  ds_read_b64_tr_b16 v[86:87], v3 offset:4256
  s_waitcnt lgkmcnt(12)
  v_mfma_f32_32x32x16_bf16 v[40:55], v[56:59], v[60:63], v[40:55]
  ds_read_b64_tr_b16 v[88:89], v3 offset:7680
  ds_read_b64_tr_b16 v[90:91], v3 offset:7920
  ds_read_b64_tr_b16 v[92:93], v3 offset:7808
  ds_read_b64_tr_b16 v[94:95], v3 offset:8048
  s_waitcnt lgkmcnt(12)
  v_mfma_f32_32x32x16_bf16 v[40:55], v[64:67], v[68:71], v[40:55]
  ds_read_b64_tr_b16 v[96:97], v3 offset:7744
  ds_read_b64_tr_b16 v[98:99], v3 offset:7984
  ds_read_b64_tr_b16 v[100:101], v3 offset:7856
  ds_read_b64_tr_b16 v[102:103], v3 offset:8096
  s_waitcnt lgkmcnt(12)
  v_mfma_f32_32x32x16_bf16 v[40:55], v[72:75], v[76:79], v[40:55]
  ds_read_b64_tr_b16 v[104:105], v3 offset:11520
  ds_read_b64_tr_b16 v[106:107], v3 offset:11760
  ds_read_b64_tr_b16 v[108:109], v3 offset:11648
  ds_read_b64_tr_b16 v[110:111], v3 offset:11888
  s_waitcnt lgkmcnt(12)
  v_mfma_f32_32x32x16_bf16 v[40:55], v[80:83], v[84:87], v[40:55]
  ds_read_b64_tr_b16 v[112:113], v3 offset:11584
  ds_read_b64_tr_b16 v[114:115], v3 offset:11824
  ds_read_b64_tr_b16 v[116:117], v3 offset:11696
  ds_read_b64_tr_b16 v[118:119], v3 offset:11936
  s_waitcnt lgkmcnt(12)
  v_mfma_f32_32x32x16_bf16 v[40:55], v[88:91], v[92:95], v[40:55]
  s_waitcnt lgkmcnt(8)
  v_mfma_f32_32x32x16_bf16 v[40:55], v[96:99], v[100:103], v[40:55]
  s_waitcnt lgkmcnt(4)
  v_mfma_f32_32x32x16_bf16 v[40:55], v[104:107], v[108:111], v[40:55]
  s_waitcnt lgkmcnt(0)
  v_mfma_f32_32x32x16_bf16 v[40:55], v[112:115], v[116:119], v[40:55]
  s_setprio 2
  s_nop 10
  ds_write_b128 v4, v[40:43] offset:0
  ds_write_b128 v4, v[44:47] offset:32
  ds_write_b128 v4, v[48:51] offset:64
  ds_write_b128 v4, v[52:55] offset:96
  v_mov_b32 v112, 0
  v_mov_b32 v113, 0
  v_mov_b32 v114, 0
  v_mov_b32 v115, 0
  s_waitcnt lgkmcnt(0)
  s_barrier
  ds_read2st64_b32 v[56:57], v120 offset1:60
  ds_read2st64_b32 v[58:59], v121 offset1:60
  ds_read2st64_b32 v[60:61], v122 offset1:60
  ds_read2st64_b32 v[62:63], v123 offset1:60
  ds_read2st64_b32 v[64:65], v124 offset1:60
  ds_read2st64_b32 v[66:67], v125 offset1:60
  ds_read2st64_b32 v[68:69], v126 offset1:60
  ds_read2st64_b32 v[70:71], v127 offset1:60
  ds_read2st64_b32 v[72:73], v128 offset1:60
  ds_read2st64_b32 v[74:75], v129 offset1:60
  ds_read2st64_b32 v[76:77], v130 offset1:60
  ds_read2st64_b32 v[78:79], v131 offset1:60
  ds_read2st64_b32 v[80:81], v132 offset1:60
  ds_read2st64_b32 v[82:83], v133 offset1:60
  ds_read2st64_b32 v[84:85], v134 offset1:60
  ds_read2st64_b32 v[86:87], v135 offset1:60
  s_mov_b64 exec, 0xffff
  ds_write_b32 v244, v112
  s_mov_b32 exec_lo, -1
  ds_write_b128 v233, v[112:115]
  s_mov_b64 exec, -1
  s_waitcnt lgkmcnt(14)
  v_add_f32 v56, v56, v57
  v_add_f32 v56, v56, v245
  v_add_f32 v58, v58, v59
  v_add_f32 v60, v60, v61
  v_add_f32 v62, v62, v63
  s_waitcnt lgkmcnt(10)
  v_add_f32 v64, v64, v65
  v_add_f32 v66, v66, v67
  v_add_f32 v68, v68, v69
  v_add_f32 v70, v70, v71
  s_waitcnt lgkmcnt(6)
  v_add_f32 v72, v72, v73
  v_add_f32 v74, v74, v75
  v_add_f32 v76, v76, v77
  v_add_f32 v78, v78, v79
  s_waitcnt lgkmcnt(2)
  v_add_f32 v80, v80, v81
  v_add_f32 v82, v82, v83
  v_add_f32 v84, v84, v85
  v_add_f32 v86, v86, v87
  v_cvt_pk_bf16_f32 v88, v56, v58
  v_cvt_pk_bf16_f32 v89, v60, v62
  v_cvt_pk_bf16_f32 v90, v64, v66
  v_cvt_pk_bf16_f32 v91, v68, v70
  v_cvt_pk_bf16_f32 v92, v72, v74
  v_cvt_pk_bf16_f32 v93, v76, v78
  v_cvt_pk_bf16_f32 v94, v80, v82
  v_cvt_pk_bf16_f32 v95, v84, v86
  ds_write_b128 v243, v[88:91] offset:64
  ds_write_b128 v243, v[92:95] offset:80
  v_mov_b32 v113, s46
  s_waitcnt lgkmcnt(0)
  s_barrier
  s_lshl_b32 s12, s3, 11
  s_add_u32 m0, s12, 0
  s_mov_b32 s13, 7168
  buffer_load_dwordx4 v7, s[64:67], 0 offen lds
  s_add_u32 m0, s12, 1024
  s_nop 0
  buffer_load_dwordx4 v7, s[64:67], s13 offen lds
  s_waitcnt vmcnt(0)
  s_barrier
  ds_read_b64_tr_b16 v[96:97], v246 offset:0
  ds_read_b64_tr_b16 v[98:99], v246 offset:2048
  ds_read_b64_tr_b16 v[100:101], v246 offset:4096
  ds_read_b64_tr_b16 v[102:103], v246 offset:6144
  s_waitcnt lgkmcnt(2)
  ds_write_b128 v247, v[96:99]
  s_waitcnt lgkmcnt(1)
  ds_write_b128 v247, v[100:103] offset:16
  s_waitcnt lgkmcnt(0)
  ds_read_b128 v[96:99], v248
  ds_read_b128 v[100:103], v248 offset:1152
  s_waitcnt lgkmcnt(1)
  buffer_store_dwordx4 v[96:99], v249, s[56:59], 0 offen sc1
  s_waitcnt lgkmcnt(0)
  buffer_store_dwordx4 v[100:103], v250, s[56:59], 0 offen sc1
  s_lshl_b32 s8, s73, 14
  s_lshr_b32 s12, s96, 3
  s_lshl_b32 s13, s12, 7
  s_add_u32 s8, s8, s13
  s_add_u32 s8, s8, 7077888
  v_lshl_add_u32 v2, v0, 9, s8
  s_and_b32 s12, s96, 7
  s_lshl_b32 s12, s12, 2
  v_mov_b32 v3, s46
  s_waitcnt vmcnt(0)
  s_barrier
  s_cmp_lg_u32 s3, 0
  s_cbranch_scc1 L_pg_25
  s_mov_b32 exec_hi, 0
  buffer_store_dword v3, v2, s[56:59], s12 offen sc1
  s_mov_b64 exec, -1
L_pg_25:
  s_lshl_b32 s8, s73, 5
  s_add_u32 s8, s8, s96
  s_lshl_b32 s8, s8, 2
  s_add_u32 s8, s8, s3
  s_lshl_b32 s8, s8, 7
  s_add_u32 s8, s8, 7077888
  s_mov_b32 s40, s46
  s_mov_b32 s41, s46
  s_mov_b32 s47, 1048576
L_sp_26:
  s_load_dwordx8 s[16:23], s[44:45], s8 glc
  s_waitcnt lgkmcnt(0)
  s_cmp_eq_u64 s[16:17], s[40:41]
  s_cbranch_scc0 L_spr_27
  s_cmp_eq_u64 s[18:19], s[40:41]
  s_cbranch_scc0 L_spr_27
  s_cmp_eq_u64 s[20:21], s[40:41]
  s_cbranch_scc0 L_spr_27
  s_cmp_eq_u64 s[22:23], s[40:41]
  s_cbranch_scc1 L_spd_28
L_spr_27:
  s_sleep 4
  s_sub_u32 s47, s47, 1
  s_cmp_gt_i32 s47, 0
  s_cbranch_scc1 L_sp_26
L_spd_28:
  s_barrier
  buffer_load_dwordx4 v[104:107], v15, s[56:59], s14 offen offset:0 sc1
  buffer_load_dwordx4 v[108:111], v15, s[56:59], s14 offen offset:1024 sc1
  s_waitcnt vmcnt(1)
  ds_write_b128 v232, v[104:107] offset:128
  s_waitcnt vmcnt(0)
  ds_write_b128 v232, v[108:111] offset:384
  s_waitcnt lgkmcnt(0)
  s_setprio 0
  s_cmp_lg_u32 s3, 0
  s_cbranch_scc1 L_trig_29
  s_lshl_b32 s8, s2, 8
  s_add_u32 s8, s8, 327684
  s_mov_b32 s40, s46
  s_mov_b32 s41, s46
  s_mov_b32 s47, 1048576
L_sp_30:
  s_load_dword s16, s[44:45], s8 glc
  s_waitcnt lgkmcnt(0)
  s_cmp_eq_u32 s16, s46
  s_cbranch_scc1 L_spd_32
L_spr_31:
  s_sleep 2
  s_sub_u32 s47, s47, 1
  s_cmp_gt_i32 s47, 0
  s_cbranch_scc1 L_sp_30
L_spd_32:
L_trig_29:
  s_barrier
  s_cmp_eq_u32 s9, 0
  s_cbranch_scc0 L_cv1_33
  ds_read_b64_tr_b16 v[144:145], v234 offset:32
  ds_read_b64_tr_b16 v[146:147], v234 offset:0
  ds_read_b128 v[108:111], v235 offset:992
  ds_read_b128 v[96:99], v235 offset:608
  ds_read_b128 v[92:95], v235 offset:480
  ds_read_b128 v[80:83], v235 offset:96
  ds_read_b64_tr_b16 v[148:149], v234 offset:544
  ds_read_b64_tr_b16 v[150:151], v234 offset:512
  ds_read_b128 v[104:107], v235 offset:864
  ds_read_b128 v[88:91], v235 offset:352
  ds_read_b64_tr_b16 v[152:153], v234 offset:1056
  ds_read_b64_tr_b16 v[154:155], v234 offset:1024
  ds_read_b128 v[100:103], v235 offset:736
  ds_read_b128 v[84:87], v235 offset:224
  ds_read_b64_tr_b16 v[156:157], v234 offset:1568
  s_waitcnt lgkmcnt(12)
  v_mfma_f32_32x32x16_bf16 v[16:31], v[144:147], v[108:111], 0
  ds_read_b64_tr_b16 v[158:159], v234 offset:1536
  s_waitcnt lgkmcnt(12)
  v_mfma_f32_32x32x16_bf16 v[32:47], v[144:147], v[96:99], 0
  ds_read_b64_tr_b16 v[160:161], v234 offset:2080
  s_waitcnt lgkmcnt(12)
  v_mfma_f32_32x32x16_bf16 v[48:63], v[144:147], v[92:95], 0
  ds_read_b64_tr_b16 v[162:163], v234 offset:2048
  s_waitcnt lgkmcnt(12)
  v_mfma_f32_32x32x16_bf16 v[64:79], v[144:147], v[80:83], 0
  ds_read_b64_tr_b16 v[164:165], v234 offset:2592
  ds_read_b64_tr_b16 v[166:167], v234 offset:2560
  ds_read_b64_tr_b16 v[168:169], v234 offset:3104
  s_waitcnt lgkmcnt(12)
  v_mfma_f32_32x32x16_bf16 v[16:31], v[148:151], v[104:107], v[16:31]
  v_mfma_f32_32x32x16_bf16 v[32:47], v[148:151], v[92:95], v[32:47]
  ds_read_b64_tr_b16 v[170:171], v234 offset:3072
  s_waitcnt lgkmcnt(12)
  v_mfma_f32_32x32x16_bf16 v[48:63], v[148:151], v[88:91], v[48:63]
  ds_read_b64_tr_b16 v[172:173], v234 offset:3616
  ds_read_b64_tr_b16 v[174:175], v234 offset:3584
  ds_read_b64_tr_b16 v[176:177], v234 offset:160
  s_waitcnt lgkmcnt(12)
  v_mfma_f32_32x32x16_bf16 v[16:31], v[152:155], v[100:103], v[16:31]
  v_mfma_f32_32x32x16_bf16 v[32:47], v[152:155], v[88:91], v[32:47]
  ds_read_b64_tr_b16 v[178:179], v234 offset:128
  s_waitcnt lgkmcnt(12)
  v_mfma_f32_32x32x16_bf16 v[48:63], v[152:155], v[84:87], v[48:63]
  ds_read_b128 v[140:143], v235 offset:960
  ds_read_b128 v[128:131], v235 offset:576
  s_waitcnt lgkmcnt(12)
  v_mfma_f32_32x32x16_bf16 v[16:31], v[156:159], v[96:99], v[16:31]
  v_mfma_f32_32x32x16_bf16 v[32:47], v[156:159], v[84:87], v[32:47]
  v_mfma_f32_32x32x16_bf16 v[48:63], v[156:159], v[80:83], v[48:63]
  ds_read_b128 v[124:127], v235 offset:448
  ds_read_b128 v[112:115], v235 offset:64
  s_waitcnt lgkmcnt(12)
  v_mfma_f32_32x32x16_bf16 v[16:31], v[160:163], v[92:95], v[16:31]
  v_mfma_f32_32x32x16_bf16 v[32:47], v[160:163], v[80:83], v[32:47]
  ds_read_b64_tr_b16 v[180:181], v234 offset:672
  ds_read_b64_tr_b16 v[182:183], v234 offset:640
  s_waitcnt lgkmcnt(12)
  v_mfma_f32_32x32x16_bf16 v[16:31], v[164:167], v[88:91], v[16:31]
  ds_read_b128 v[136:139], v235 offset:832
  ds_read_b128 v[120:123], v235 offset:320
  s_waitcnt lgkmcnt(12)
  v_mfma_f32_32x32x16_bf16 v[16:31], v[168:171], v[84:87], v[16:31]
  ds_read_b64_tr_b16 v[184:185], v234 offset:1184
  ds_read_b64_tr_b16 v[186:187], v234 offset:1152
  s_waitcnt lgkmcnt(12)
  v_mfma_f32_32x32x16_bf16 v[16:31], v[172:175], v[80:83], v[16:31]
  ds_read_b128 v[132:135], v235 offset:704
  ds_read_b128 v[116:119], v235 offset:192
  ds_read_b64_tr_b16 v[188:189], v234 offset:1696
  s_waitcnt lgkmcnt(12)
  v_mfma_f32_32x32x16_bf16 v[16:31], v[176:179], v[140:143], v[16:31]
  ds_read_b64_tr_b16 v[190:191], v234 offset:1664
  s_waitcnt lgkmcnt(12)
  v_mfma_f32_32x32x16_bf16 v[32:47], v[176:179], v[128:131], v[32:47]
  ds_read_b64_tr_b16 v[192:193], v234 offset:2208
  s_waitcnt lgkmcnt(12)
  v_mfma_f32_32x32x16_bf16 v[48:63], v[176:179], v[124:127], v[48:63]
  ds_read_b64_tr_b16 v[194:195], v234 offset:2176
  s_waitcnt lgkmcnt(12)
  v_mfma_f32_32x32x16_bf16 v[64:79], v[176:179], v[112:115], v[64:79]
  ds_read_b64_tr_b16 v[196:197], v234 offset:2720
  ds_read_b64_tr_b16 v[198:199], v234 offset:2688
  ds_read_b64_tr_b16 v[200:201], v234 offset:3232
  s_waitcnt lgkmcnt(12)
  v_mfma_f32_32x32x16_bf16 v[16:31], v[180:183], v[136:139], v[16:31]
  v_mfma_f32_32x32x16_bf16 v[32:47], v[180:183], v[124:127], v[32:47]
  ds_read_b64_tr_b16 v[202:203], v234 offset:3200
  s_waitcnt lgkmcnt(12)
  v_mfma_f32_32x32x16_bf16 v[48:63], v[180:183], v[120:123], v[48:63]
  ds_read_b64_tr_b16 v[204:205], v234 offset:3744
  ds_read_b64_tr_b16 v[206:207], v234 offset:3712
  ds_read_b64_tr_b16 v[144:145], v234 offset:288
  s_waitcnt lgkmcnt(12)
  v_mfma_f32_32x32x16_bf16 v[16:31], v[184:187], v[132:135], v[16:31]
  v_mfma_f32_32x32x16_bf16 v[32:47], v[184:187], v[120:123], v[32:47]
  ds_read_b64_tr_b16 v[146:147], v234 offset:256
  s_waitcnt lgkmcnt(12)
  v_mfma_f32_32x32x16_bf16 v[48:63], v[184:187], v[116:119], v[48:63]
  ds_read_b128 v[108:111], v235 offset:928
  ds_read_b128 v[96:99], v235 offset:544
  s_waitcnt lgkmcnt(12)
  v_mfma_f32_32x32x16_bf16 v[16:31], v[188:191], v[128:131], v[16:31]
  v_mfma_f32_32x32x16_bf16 v[32:47], v[188:191], v[116:119], v[32:47]
  v_mfma_f32_32x32x16_bf16 v[48:63], v[188:191], v[112:115], v[48:63]
  ds_read_b128 v[92:95], v235 offset:416
  ds_read_b128 v[80:83], v235 offset:32
  s_waitcnt lgkmcnt(12)
  v_mfma_f32_32x32x16_bf16 v[16:31], v[192:195], v[124:127], v[16:31]
  v_mfma_f32_32x32x16_bf16 v[32:47], v[192:195], v[112:115], v[32:47]
  ds_read_b64_tr_b16 v[148:149], v234 offset:800
  ds_read_b64_tr_b16 v[150:151], v234 offset:768
  s_waitcnt lgkmcnt(12)
  v_mfma_f32_32x32x16_bf16 v[16:31], v[196:199], v[120:123], v[16:31]
  ds_read_b128 v[104:107], v235 offset:800
  ds_read_b128 v[88:91], v235 offset:288
  s_waitcnt lgkmcnt(12)
  v_mfma_f32_32x32x16_bf16 v[16:31], v[200:203], v[116:119], v[16:31]
  ds_read_b64_tr_b16 v[152:153], v234 offset:1312
  ds_read_b64_tr_b16 v[154:155], v234 offset:1280
  s_waitcnt lgkmcnt(12)
  v_mfma_f32_32x32x16_bf16 v[16:31], v[204:207], v[112:115], v[16:31]
  ds_read_b128 v[100:103], v235 offset:672
  ds_read_b128 v[84:87], v235 offset:160
  ds_read_b64_tr_b16 v[156:157], v234 offset:1824
  s_waitcnt lgkmcnt(12)
  v_mfma_f32_32x32x16_bf16 v[16:31], v[144:147], v[108:111], v[16:31]
  ds_read_b64_tr_b16 v[158:159], v234 offset:1792
  ds_read_b64_tr_b16 v[160:161], v234 offset:2336
  s_waitcnt lgkmcnt(13)
  v_mfma_f32_32x32x16_bf16 v[32:47], v[144:147], v[96:99], v[32:47]
  ds_read_b64_tr_b16 v[162:163], v234 offset:2304
  ds_read_b64_tr_b16 v[164:165], v234 offset:2848
  s_waitcnt lgkmcnt(14)
  v_mfma_f32_32x32x16_bf16 v[48:63], v[144:147], v[92:95], v[48:63]
  ds_read_b64_tr_b16 v[166:167], v234 offset:2816
  ds_read_b64_tr_b16 v[168:169], v234 offset:3360
  s_waitcnt lgkmcnt(14)
  v_mfma_f32_32x32x16_bf16 v[64:79], v[144:147], v[80:83], v[64:79]
  ds_read_b64_tr_b16 v[170:171], v234 offset:3328
  ds_read_b64_tr_b16 v[172:173], v234 offset:3872
  s_waitcnt lgkmcnt(14)
  v_mfma_f32_32x32x16_bf16 v[16:31], v[148:151], v[104:107], v[16:31]
  ds_read_b64_tr_b16 v[174:175], v234 offset:3840
  ds_read_b64_tr_b16 v[176:177], v234 offset:416
  v_mfma_f32_32x32x16_bf16 v[32:47], v[148:151], v[92:95], v[32:47]
  ds_read_b64_tr_b16 v[178:179], v234 offset:384
  ds_read_b128 v[140:143], v235 offset:896
  s_waitcnt lgkmcnt(14)
  v_mfma_f32_32x32x16_bf16 v[48:63], v[148:151], v[88:91], v[48:63]
  ds_read_b128 v[128:131], v235 offset:512
  ds_read_b128 v[124:127], v235 offset:384
  v_mfma_f32_32x32x16_bf16 v[16:31], v[152:155], v[100:103], v[16:31]
  ds_read_b128 v[112:115], v235 offset:0
  ds_read_b64_tr_b16 v[180:181], v234 offset:928
  v_mfma_f32_32x32x16_bf16 v[32:47], v[152:155], v[88:91], v[32:47]
  ds_read_b64_tr_b16 v[182:183], v234 offset:896
  ds_read_b128 v[136:139], v235 offset:768
  s_waitcnt lgkmcnt(14)
  v_mfma_f32_32x32x16_bf16 v[48:63], v[152:155], v[84:87], v[48:63]
  ds_read_b128 v[120:123], v235 offset:256
  ds_read_b64_tr_b16 v[184:185], v234 offset:1440
  v_mfma_f32_32x32x16_bf16 v[16:31], v[156:159], v[96:99], v[16:31]
  ds_read_b64_tr_b16 v[186:187], v234 offset:1408
  ds_read_b128 v[132:135], v235 offset:640
  v_mfma_f32_32x32x16_bf16 v[32:47], v[156:159], v[84:87], v[32:47]
  ds_read_b128 v[116:119], v235 offset:128
  ds_read_b64_tr_b16 v[188:189], v234 offset:1952
  v_mfma_f32_32x32x16_bf16 v[48:63], v[156:159], v[80:83], v[48:63]
  ds_read_b64_tr_b16 v[190:191], v234 offset:1920
  ds_read_b64_tr_b16 v[192:193], v234 offset:2464
  v_mfma_f32_32x32x16_bf16 v[16:31], v[160:163], v[92:95], v[16:31]
  ds_read_b64_tr_b16 v[194:195], v234 offset:2432
  v_mfma_f32_32x32x16_bf16 v[32:47], v[160:163], v[80:83], v[32:47]
  ds_read_b64_tr_b16 v[196:197], v234 offset:2976
  ds_read_b64_tr_b16 v[198:199], v234 offset:2944
  s_waitcnt lgkmcnt(14)
  v_mfma_f32_32x32x16_bf16 v[16:31], v[164:167], v[88:91], v[16:31]
  ds_read_b64_tr_b16 v[200:201], v234 offset:3488
  ds_read_b64_tr_b16 v[202:203], v234 offset:3456
  v_mfma_f32_32x32x16_bf16 v[16:31], v[168:171], v[84:87], v[16:31]
  ds_read_b64_tr_b16 v[204:205], v234 offset:4000
  ds_read_b64_tr_b16 v[206:207], v234 offset:3968
  v_mfma_f32_32x32x16_bf16 v[16:31], v[172:175], v[80:83], v[16:31]
  s_waitcnt lgkmcnt(0)
  s_barrier
  v_mfma_f32_32x32x16_bf16 v[16:31], v[176:179], v[140:143], v[16:31]
  v_mfma_f32_32x32x16_bf16 v[32:47], v[176:179], v[128:131], v[32:47]
  v_mfma_f32_32x32x16_bf16 v[48:63], v[176:179], v[124:127], v[48:63]
  v_mfma_f32_32x32x16_bf16 v[64:79], v[176:179], v[112:115], v[64:79]
  v_mfma_f32_32x32x16_bf16 v[16:31], v[180:183], v[136:139], v[16:31]
  v_mfma_f32_32x32x16_bf16 v[32:47], v[180:183], v[124:127], v[32:47]
  v_mfma_f32_32x32x16_bf16 v[48:63], v[180:183], v[120:123], v[48:63]
  v_mfma_f32_32x32x16_bf16 v[16:31], v[184:187], v[132:135], v[16:31]
  v_mfma_f32_32x32x16_bf16 v[32:47], v[184:187], v[120:123], v[32:47]
  s_nop 6
  ds_write_b128 v236, v[64:67] offset:0
  v_mfma_f32_32x32x16_bf16 v[48:63], v[184:187], v[116:119], v[48:63]
  ds_write_b128 v237, v[68:71] offset:0
  v_mfma_f32_32x32x16_bf16 v[16:31], v[188:191], v[128:131], v[16:31]
  ds_write_b128 v238, v[72:75] offset:0
  v_mfma_f32_32x32x16_bf16 v[32:47], v[188:191], v[116:119], v[32:47]
  ds_write_b128 v239, v[76:79] offset:0
  v_mfma_f32_32x32x16_bf16 v[48:63], v[188:191], v[112:115], v[48:63]
  v_mfma_f32_32x32x16_bf16 v[16:31], v[192:195], v[124:127], v[16:31]
  v_mfma_f32_32x32x16_bf16 v[32:47], v[192:195], v[112:115], v[32:47]
  v_mfma_f32_32x32x16_bf16 v[16:31], v[196:199], v[120:123], v[16:31]
  v_mfma_f32_32x32x16_bf16 v[16:31], v[200:203], v[116:119], v[16:31]
  v_mfma_f32_32x32x16_bf16 v[16:31], v[204:207], v[112:115], v[16:31]
  s_nop 6
  ds_write_b128 v236, v[48:51] offset:3072
  ds_write_b128 v237, v[52:55] offset:3072
  ds_write_b128 v238, v[56:59] offset:3072
  ds_write_b128 v239, v[60:63] offset:3072
  ds_write_b128 v236, v[32:35] offset:4096
  ds_write_b128 v237, v[36:39] offset:4096
  ds_write_b128 v238, v[40:43] offset:4096
  ds_write_b128 v239, v[44:47] offset:4096
  ds_write_b128 v236, v[16:19] offset:7168
  ds_write_b128 v237, v[20:23] offset:7168
  ds_write_b128 v238, v[24:27] offset:7168
  ds_write_b128 v239, v[28:31] offset:7168
  s_branch L_cvj_34
L_cv1_33:
  ds_read_b64_tr_b16 v[144:145], v234 offset:32
  ds_read_b64_tr_b16 v[146:147], v234 offset:0
  ds_read_b128 v[104:107], v235 offset:864
  ds_read_b128 v[100:103], v235 offset:736
  ds_read_b128 v[88:91], v235 offset:352
  ds_read_b128 v[84:87], v235 offset:224
  ds_read_b64_tr_b16 v[148:149], v234 offset:544
  ds_read_b64_tr_b16 v[150:151], v234 offset:512
  ds_read_b128 v[96:99], v235 offset:608
  ds_read_b128 v[80:83], v235 offset:96
  ds_read_b64_tr_b16 v[152:153], v234 offset:1056
  ds_read_b64_tr_b16 v[154:155], v234 offset:1024
  ds_read_b128 v[92:95], v235 offset:480
  ds_read_b64_tr_b16 v[156:157], v234 offset:1568
  ds_read_b64_tr_b16 v[158:159], v234 offset:1536
  s_waitcnt lgkmcnt(12)
  v_mfma_f32_32x32x16_bf16 v[16:31], v[144:147], v[104:107], 0
  ds_read_b64_tr_b16 v[160:161], v234 offset:2080
  s_waitcnt lgkmcnt(12)
  v_mfma_f32_32x32x16_bf16 v[32:47], v[144:147], v[100:103], 0
  ds_read_b64_tr_b16 v[162:163], v234 offset:2048
  s_waitcnt lgkmcnt(12)
  v_mfma_f32_32x32x16_bf16 v[48:63], v[144:147], v[88:91], 0
  ds_read_b64_tr_b16 v[164:165], v234 offset:2592
  s_waitcnt lgkmcnt(12)
  v_mfma_f32_32x32x16_bf16 v[64:79], v[144:147], v[84:87], 0
  ds_read_b64_tr_b16 v[166:167], v234 offset:2560
  ds_read_b64_tr_b16 v[168:169], v234 offset:3104
  s_waitcnt lgkmcnt(12)
  v_mfma_f32_32x32x16_bf16 v[16:31], v[148:151], v[100:103], v[16:31]
  ds_read_b64_tr_b16 v[170:171], v234 offset:3072
  s_waitcnt lgkmcnt(12)
  v_mfma_f32_32x32x16_bf16 v[32:47], v[148:151], v[96:99], v[32:47]
  v_mfma_f32_32x32x16_bf16 v[48:63], v[148:151], v[84:87], v[48:63]
  ds_read_b64_tr_b16 v[176:177], v234 offset:160
  s_waitcnt lgkmcnt(12)
  v_mfma_f32_32x32x16_bf16 v[64:79], v[148:151], v[80:83], v[64:79]
  ds_read_b64_tr_b16 v[178:179], v234 offset:128
  ds_read_b128 v[136:139], v235 offset:832
  s_waitcnt lgkmcnt(12)
  v_mfma_f32_32x32x16_bf16 v[16:31], v[152:155], v[96:99], v[16:31]
  ds_read_b128 v[132:135], v235 offset:704
  s_waitcnt lgkmcnt(12)
  v_mfma_f32_32x32x16_bf16 v[32:47], v[152:155], v[92:95], v[32:47]
  v_mfma_f32_32x32x16_bf16 v[48:63], v[152:155], v[80:83], v[48:63]
  ds_read_b128 v[120:123], v235 offset:320
  ds_read_b128 v[116:119], v235 offset:192
  s_waitcnt lgkmcnt(12)
  v_mfma_f32_32x32x16_bf16 v[16:31], v[156:159], v[92:95], v[16:31]
  v_mfma_f32_32x32x16_bf16 v[32:47], v[156:159], v[88:91], v[32:47]
  ds_read_b64_tr_b16 v[180:181], v234 offset:672
  ds_read_b64_tr_b16 v[182:183], v234 offset:640
  s_waitcnt lgkmcnt(12)
  v_mfma_f32_32x32x16_bf16 v[16:31], v[160:163], v[88:91], v[16:31]
  v_mfma_f32_32x32x16_bf16 v[32:47], v[160:163], v[84:87], v[32:47]
  ds_read_b128 v[128:131], v235 offset:576
  ds_read_b128 v[112:115], v235 offset:64
  s_waitcnt lgkmcnt(12)
  v_mfma_f32_32x32x16_bf16 v[16:31], v[164:167], v[84:87], v[16:31]
  v_mfma_f32_32x32x16_bf16 v[32:47], v[164:167], v[80:83], v[32:47]
  ds_read_b64_tr_b16 v[184:185], v234 offset:1184
  ds_read_b64_tr_b16 v[186:187], v234 offset:1152
  s_waitcnt lgkmcnt(12)
  v_mfma_f32_32x32x16_bf16 v[16:31], v[168:171], v[80:83], v[16:31]
  ds_read_b128 v[124:127], v235 offset:448
  ds_read_b64_tr_b16 v[188:189], v234 offset:1696
  ds_read_b64_tr_b16 v[190:191], v234 offset:1664
  s_waitcnt lgkmcnt(12)
  v_mfma_f32_32x32x16_bf16 v[16:31], v[176:179], v[136:139], v[16:31]
  ds_read_b64_tr_b16 v[192:193], v234 offset:2208
  s_waitcnt lgkmcnt(12)
  v_mfma_f32_32x32x16_bf16 v[32:47], v[176:179], v[132:135], v[32:47]
  ds_read_b64_tr_b16 v[194:195], v234 offset:2176
  s_waitcnt lgkmcnt(12)
  v_mfma_f32_32x32x16_bf16 v[48:63], v[176:179], v[120:123], v[48:63]
  ds_read_b64_tr_b16 v[196:197], v234 offset:2720
  s_waitcnt lgkmcnt(12)
  v_mfma_f32_32x32x16_bf16 v[64:79], v[176:179], v[116:119], v[64:79]
  ds_read_b64_tr_b16 v[198:199], v234 offset:2688
  ds_read_b64_tr_b16 v[200:201], v234 offset:3232
  s_waitcnt lgkmcnt(12)
  v_mfma_f32_32x32x16_bf16 v[16:31], v[180:183], v[132:135], v[16:31]
  ds_read_b64_tr_b16 v[202:203], v234 offset:3200
  s_waitcnt lgkmcnt(12)
  v_mfma_f32_32x32x16_bf16 v[32:47], v[180:183], v[128:131], v[32:47]
  v_mfma_f32_32x32x16_bf16 v[48:63], v[180:183], v[116:119], v[48:63]
  ds_read_b64_tr_b16 v[144:145], v234 offset:288
  s_waitcnt lgkmcnt(12)
  v_mfma_f32_32x32x16_bf16 v[64:79], v[180:183], v[112:115], v[64:79]
  ds_read_b64_tr_b16 v[146:147], v234 offset:256
  ds_read_b128 v[104:107], v235 offset:800
  s_waitcnt lgkmcnt(12)
  v_mfma_f32_32x32x16_bf16 v[16:31], v[184:187], v[128:131], v[16:31]
  ds_read_b128 v[100:103], v235 offset:672
  s_waitcnt lgkmcnt(12)
  v_mfma_f32_32x32x16_bf16 v[32:47], v[184:187], v[124:127], v[32:47]
  v_mfma_f32_32x32x16_bf16 v[48:63], v[184:187], v[112:115], v[48:63]
  ds_read_b128 v[88:91], v235 offset:288
  ds_read_b128 v[84:87], v235 offset:160
  s_waitcnt lgkmcnt(12)
  v_mfma_f32_32x32x16_bf16 v[16:31], v[188:191], v[124:127], v[16:31]
  v_mfma_f32_32x32x16_bf16 v[32:47], v[188:191], v[120:123], v[32:47]
  ds_read_b64_tr_b16 v[148:149], v234 offset:800
  ds_read_b64_tr_b16 v[150:151], v234 offset:768
  s_waitcnt lgkmcnt(12)
  v_mfma_f32_32x32x16_bf16 v[16:31], v[192:195], v[120:123], v[16:31]
  v_mfma_f32_32x32x16_bf16 v[32:47], v[192:195], v[116:119], v[32:47]
  ds_read_b128 v[96:99], v235 offset:544
  ds_read_b128 v[80:83], v235 offset:32
  s_waitcnt lgkmcnt(12)
  v_mfma_f32_32x32x16_bf16 v[16:31], v[196:199], v[116:119], v[16:31]
  v_mfma_f32_32x32x16_bf16 v[32:47], v[196:199], v[112:115], v[32:47]
  ds_read_b64_tr_b16 v[152:153], v234 offset:1312
  ds_read_b64_tr_b16 v[154:155], v234 offset:1280
  s_waitcnt lgkmcnt(12)
  v_mfma_f32_32x32x16_bf16 v[16:31], v[200:203], v[112:115], v[16:31]
  ds_read_b128 v[92:95], v235 offset:416
  ds_read_b64_tr_b16 v[156:157], v234 offset:1824
  ds_read_b64_tr_b16 v[158:159], v234 offset:1792
  s_waitcnt lgkmcnt(12)
  v_mfma_f32_32x32x16_bf16 v[16:31], v[144:147], v[104:107], v[16:31]
  ds_read_b64_tr_b16 v[160:161], v234 offset:2336
  ds_read_b64_tr_b16 v[162:163], v234 offset:2304
  s_waitcnt lgkmcnt(13)
  v_mfma_f32_32x32x16_bf16 v[32:47], v[144:147], v[100:103], v[32:47]
  ds_read_b64_tr_b16 v[164:165], v234 offset:2848
  ds_read_b64_tr_b16 v[166:167], v234 offset:2816
  s_waitcnt lgkmcnt(14)
  v_mfma_f32_32x32x16_bf16 v[48:63], v[144:147], v[88:91], v[48:63]
  ds_read_b64_tr_b16 v[168:169], v234 offset:3360
  ds_read_b64_tr_b16 v[170:171], v234 offset:3328
  s_waitcnt lgkmcnt(14)
  v_mfma_f32_32x32x16_bf16 v[64:79], v[144:147], v[84:87], v[64:79]
  ds_read_b64_tr_b16 v[176:177], v234 offset:416
  ds_read_b64_tr_b16 v[178:179], v234 offset:384
  s_waitcnt lgkmcnt(14)
  v_mfma_f32_32x32x16_bf16 v[16:31], v[148:151], v[100:103], v[16:31]
  ds_read_b128 v[136:139], v235 offset:768
  ds_read_b128 v[132:135], v235 offset:640
  v_mfma_f32_32x32x16_bf16 v[32:47], v[148:151], v[96:99], v[32:47]
  ds_read_b128 v[120:123], v235 offset:256
  ds_read_b128 v[116:119], v235 offset:128
  v_mfma_f32_32x32x16_bf16 v[48:63], v[148:151], v[84:87], v[48:63]
  ds_read_b64_tr_b16 v[180:181], v234 offset:928
  ds_read_b64_tr_b16 v[182:183], v234 offset:896
  s_waitcnt lgkmcnt(14)
  v_mfma_f32_32x32x16_bf16 v[64:79], v[148:151], v[80:83], v[64:79]
  ds_read_b128 v[128:131], v235 offset:512
  ds_read_b128 v[112:115], v235 offset:0
  v_mfma_f32_32x32x16_bf16 v[16:31], v[152:155], v[96:99], v[16:31]
  ds_read_b64_tr_b16 v[184:185], v234 offset:1440
  ds_read_b64_tr_b16 v[186:187], v234 offset:1408
  v_mfma_f32_32x32x16_bf16 v[32:47], v[152:155], v[92:95], v[32:47]
  ds_read_b128 v[124:127], v235 offset:384
  ds_read_b64_tr_b16 v[188:189], v234 offset:1952
  v_mfma_f32_32x32x16_bf16 v[48:63], v[152:155], v[80:83], v[48:63]
  ds_read_b64_tr_b16 v[190:191], v234 offset:1920
  ds_read_b64_tr_b16 v[192:193], v234 offset:2464
  v_mfma_f32_32x32x16_bf16 v[16:31], v[156:159], v[92:95], v[16:31]
  ds_read_b64_tr_b16 v[194:195], v234 offset:2432
  ds_read_b64_tr_b16 v[196:197], v234 offset:2976
  v_mfma_f32_32x32x16_bf16 v[32:47], v[156:159], v[88:91], v[32:47]
  ds_read_b64_tr_b16 v[198:199], v234 offset:2944
  ds_read_b64_tr_b16 v[200:201], v234 offset:3488
  s_waitcnt lgkmcnt(14)
  v_mfma_f32_32x32x16_bf16 v[16:31], v[160:163], v[88:91], v[16:31]
  v_mfma_f32_32x32x16_bf16 v[32:47], v[160:163], v[84:87], v[32:47]
  ds_read_b64_tr_b16 v[202:203], v234 offset:3456
  v_mfma_f32_32x32x16_bf16 v[16:31], v[164:167], v[84:87], v[16:31]
  v_mfma_f32_32x32x16_bf16 v[32:47], v[164:167], v[80:83], v[32:47]
  v_mfma_f32_32x32x16_bf16 v[16:31], v[168:171], v[80:83], v[16:31]
  s_waitcnt lgkmcnt(0)
  s_barrier
  v_mfma_f32_32x32x16_bf16 v[16:31], v[176:179], v[136:139], v[16:31]
  v_mfma_f32_32x32x16_bf16 v[32:47], v[176:179], v[132:135], v[32:47]
  v_mfma_f32_32x32x16_bf16 v[48:63], v[176:179], v[120:123], v[48:63]
  v_mfma_f32_32x32x16_bf16 v[64:79], v[176:179], v[116:119], v[64:79]
  v_mfma_f32_32x32x16_bf16 v[16:31], v[180:183], v[132:135], v[16:31]
  v_mfma_f32_32x32x16_bf16 v[32:47], v[180:183], v[128:131], v[32:47]
  v_mfma_f32_32x32x16_bf16 v[48:63], v[180:183], v[116:119], v[48:63]
  v_mfma_f32_32x32x16_bf16 v[64:79], v[180:183], v[112:115], v[64:79]
  v_mfma_f32_32x32x16_bf16 v[16:31], v[184:187], v[128:131], v[16:31]
  v_mfma_f32_32x32x16_bf16 v[32:47], v[184:187], v[124:127], v[32:47]
  v_mfma_f32_32x32x16_bf16 v[48:63], v[184:187], v[112:115], v[48:63]
  v_mfma_f32_32x32x16_bf16 v[16:31], v[188:191], v[124:127], v[16:31]
  v_mfma_f32_32x32x16_bf16 v[32:47], v[188:191], v[120:123], v[32:47]
  s_nop 6
  ds_write_b128 v236, v[64:67] offset:1024
  v_mfma_f32_32x32x16_bf16 v[16:31], v[192:195], v[120:123], v[16:31]
  ds_write_b128 v237, v[68:71] offset:1024
  v_mfma_f32_32x32x16_bf16 v[32:47], v[192:195], v[116:119], v[32:47]
  ds_write_b128 v238, v[72:75] offset:1024
  v_mfma_f32_32x32x16_bf16 v[16:31], v[196:199], v[116:119], v[16:31]
  ds_write_b128 v239, v[76:79] offset:1024
  v_mfma_f32_32x32x16_bf16 v[32:47], v[196:199], v[112:115], v[32:47]
  ds_write_b128 v236, v[48:51] offset:2048
  v_mfma_f32_32x32x16_bf16 v[16:31], v[200:203], v[112:115], v[16:31]
  ds_write_b128 v237, v[52:55] offset:2048
  ds_write_b128 v238, v[56:59] offset:2048
  ds_write_b128 v239, v[60:63] offset:2048
  s_nop 6
  ds_write_b128 v236, v[32:35] offset:5120
  ds_write_b128 v237, v[36:39] offset:5120
  ds_write_b128 v238, v[40:43] offset:5120
  ds_write_b128 v239, v[44:47] offset:5120
  ds_write_b128 v236, v[16:19] offset:6144
  ds_write_b128 v237, v[20:23] offset:6144
  ds_write_b128 v238, v[24:27] offset:6144
  ds_write_b128 v239, v[28:31] offset:6144
L_cvj_34:
  s_setprio 3
  s_waitcnt lgkmcnt(0)
  s_barrier
  ds_read_b128 v[16:19], v240 offset:0
  ds_read_b128 v[20:23], v241 offset:0
  ds_read_b128 v[24:27], v242 offset:0
  ds_read_b128 v[28:31], v240 offset:8192
  ds_read_b128 v[32:35], v241 offset:8192
  ds_read_b128 v[36:39], v242 offset:8192
  ds_read_b128 v[40:43], v240 offset:16384
  ds_read_b128 v[44:47], v241 offset:16384
  ds_read_b128 v[48:51], v242 offset:16384
  ds_read_b128 v[52:55], v240 offset:24576
  ds_read_b128 v[56:59], v241 offset:24576
  ds_read_b128 v[60:63], v240 offset:2048
  ds_read_b128 v[64:67], v241 offset:2048
  ds_read_b128 v[68:71], v242 offset:2048
  ds_read_b128 v[72:75], v240 offset:10240
  ds_read_b128 v[76:79], v241 offset:10240
  ds_read_b128 v[80:83], v242 offset:10240
  ds_read_b128 v[84:87], v240 offset:18432
  ds_read_b128 v[88:91], v241 offset:18432
  ds_read_b128 v[92:95], v242 offset:18432
  ds_read_b128 v[96:99], v240 offset:26624
  ds_read_b128 v[100:103], v241 offset:26624
  s_waitcnt lgkmcnt(14)
  s_mov_b32 exec_lo, s93
  s_mov_b32 exec_hi, 0
  v_mov_b32 v27, 0
  s_mov_b64 exec, -1
  v_add_f32 v16, v16, v27
  v_add_f32 v17, v17, v28
  v_add_f32 v18, v18, v29
  v_add_f32 v19, v19, v30
  v_add_f32 v20, v20, v31
  v_add_f32 v21, v21, v32
  v_add_f32 v22, v22, v33
  v_add_f32 v23, v23, v34
  s_waitcnt lgkmcnt(14)
  s_mov_b32 exec_lo, s93
  s_mov_b32 exec_hi, 0
  v_mov_b32 v38, 0
  v_mov_b32 v39, 0
  s_mov_b64 exec, -1
  v_add_f32 v16, v16, v38
  v_add_f32 v17, v17, v39
  v_add_f32 v18, v18, v40
  v_add_f32 v19, v19, v41
  v_add_f32 v20, v20, v42
  v_add_f32 v21, v21, v43
  v_add_f32 v22, v22, v44
  v_add_f32 v23, v23, v45
  s_waitcnt lgkmcnt(11)
  s_mov_b32 exec_lo, s93
  s_mov_b32 exec_hi, 0
  v_mov_b32 v49, 0
  v_mov_b32 v50, 0
  v_mov_b32 v51, 0
  s_mov_b64 exec, -1
  v_add_f32 v16, v16, v49
  v_add_f32 v17, v17, v50
  v_add_f32 v18, v18, v51
  v_add_f32 v19, v19, v52
  v_add_f32 v20, v20, v53
  v_add_f32 v21, v21, v54
  v_add_f32 v22, v22, v55
  v_add_f32 v23, v23, v56
  v_cvt_pk_bf16_f32 v104, v16, v17
  v_cvt_pk_bf16_f32 v105, v18, v19
  v_cvt_pk_bf16_f32 v106, v20, v21
  v_cvt_pk_bf16_f32 v107, v22, v23
  buffer_store_dwordx4 v[104:107], v15, s[56:59], s92 offen offset:0 sc1
  s_waitcnt lgkmcnt(6)
  v_add_f32 v60, v60, v71
  v_add_f32 v61, v61, v72
  v_add_f32 v62, v62, v73
  v_add_f32 v63, v63, v74
  v_add_f32 v64, v64, v75
  v_add_f32 v65, v65, v76
  v_add_f32 v66, v66, v77
  v_add_f32 v67, v67, v78
  s_waitcnt lgkmcnt(3)
  v_add_f32 v60, v60, v82
  v_add_f32 v61, v61, v83
  v_add_f32 v62, v62, v84
  v_add_f32 v63, v63, v85
  v_add_f32 v64, v64, v86
  v_add_f32 v65, v65, v87
  v_add_f32 v66, v66, v88
  v_add_f32 v67, v67, v89
  s_waitcnt lgkmcnt(0)
  v_add_f32 v60, v60, v93
  v_add_f32 v61, v61, v94
  v_add_f32 v62, v62, v95
  v_add_f32 v63, v63, v96
  v_add_f32 v64, v64, v97
  v_add_f32 v65, v65, v98
  v_add_f32 v66, v66, v99
  v_add_f32 v67, v67, v100
  v_cvt_pk_bf16_f32 v108, v60, v61
  v_cvt_pk_bf16_f32 v109, v62, v63
  v_cvt_pk_bf16_f32 v110, v64, v65
  v_cvt_pk_bf16_f32 v111, v66, v67
  buffer_store_dwordx4 v[108:111], v15, s[56:59], s92 offen offset:1024 sc1
  s_lshl_b32 s8, s73, 14
  s_lshr_b32 s12, s96, 3
  s_lshl_b32 s13, s12, 7
  s_add_u32 s8, s8, s13
  s_add_u32 s8, s8, 917504
  v_lshl_add_u32 v2, v0, 9, s8
  s_and_b32 s12, s96, 7
  s_lshl_b32 s12, s12, 2
  v_mov_b32 v3, s46
  s_waitcnt vmcnt(0)
  s_barrier
  s_cmp_lg_u32 s3, 0
  s_cbranch_scc1 L_pg_35
  s_mov_b32 exec_hi, 0
  buffer_store_dword v3, v2, s[56:59], s12 offen sc1
  s_mov_b64 exec, -1
L_pg_35:
  s_lshl_b32 s8, s73, 5
  s_add_u32 s8, s8, s96
  s_lshl_b32 s8, s8, 2
  s_add_u32 s8, s8, s3
  s_lshl_b32 s8, s8, 7
  s_add_u32 s8, s8, 917504
  s_mov_b32 s40, s46
  s_mov_b32 s41, s46
  s_mov_b32 s47, 1048576
L_sp_36:
  s_load_dwordx8 s[16:23], s[44:45], s8 glc
  s_waitcnt lgkmcnt(0)
  s_cmp_eq_u64 s[16:17], s[40:41]
  s_cbranch_scc0 L_spr_37
  s_cmp_eq_u64 s[18:19], s[40:41]
  s_cbranch_scc0 L_spr_37
  s_cmp_eq_u64 s[20:21], s[40:41]
  s_cbranch_scc0 L_spr_37
  s_cmp_eq_u64 s[22:23], s[40:41]
  s_cbranch_scc1 L_spd_38
L_spr_37:
  s_sub_u32 s47, s47, 1
  s_cmp_gt_i32 s47, 0
  s_cbranch_scc1 L_sp_36
L_spd_38:
  s_barrier
  buffer_load_dwordx4 v[16:19], v251, s[56:59], s37 offen sc1
  buffer_load_dwordx4 v[20:23], v251, s[56:59], s38 offen sc1
  s_waitcnt vmcnt(1)
  ds_write_b128 v252, v[16:19]
  s_waitcnt vmcnt(0)
  ds_write_b128 v252, v[20:23] offset:5120
  s_waitcnt lgkmcnt(0)
  s_barrier
  ds_read_b64_tr_b16 v[24:25], v253 offset:0
  ds_read_b64_tr_b16 v[26:27], v253 offset:640
  ds_read_b64_tr_b16 v[28:29], v253 offset:5120
  ds_read_b64_tr_b16 v[30:31], v253 offset:5760
  s_waitcnt lgkmcnt(2)
  ds_write_b128 v255, v[24:27]
  s_waitcnt lgkmcnt(1)
  ds_write_b128 v255, v[28:31] offset:64
  s_waitcnt lgkmcnt(0)
  ds_read_b128 v[24:27], v248 offset:4096
  ds_read_b128 v[28:31], v248 offset:5248
  s_waitcnt lgkmcnt(1)
  buffer_store_dwordx4 v[24:27], v254, s[60:63], s39 offen sc1
  s_waitcnt lgkmcnt(0)
  buffer_store_dwordx4 v[28:31], v254, s[60:63], s94 offen sc1
  s_endpgm
L_idle_2:
  s_mov_b32 s64, s38
  s_mov_b32 s65, s39
  s_mov_b32 s66, 0x62000
  s_mov_b32 s67, 0x20000
  s_waitcnt vmcnt(1) lgkmcnt(0)
  v_readfirstlane_b32 s46, v54
  s_nop 0
  s_add_u32 s46, s46, 0x9e3779b9
  s_cmp_lt_u32 s4, 4
  s_cbranch_scc1 L_ih_39
  s_lshl_b32 s8, s2, 8
  s_add_u32 s8, s8, 327680
  s_mov_b32 s40, s46
  s_mov_b32 s41, s46
  s_mov_b32 s47, 1048576
L_sp_40:
  s_load_dword s16, s[44:45], s8 glc
  s_waitcnt lgkmcnt(0)
  s_cmp_eq_u32 s16, s46
  s_cbranch_scc1 L_spd_42
L_spr_41:
  s_sleep 1
  s_sub_u32 s47, s47, 1
  s_cmp_gt_i32 s47, 0
  s_cbranch_scc1 L_sp_40
L_spd_42:
  s_mul_i32 s12, s10, 384
  s_mul_i32 s13, s10, 6144
  s_lshl_b32 s8, s9, 10
  s_add_u32 s13, s13, s8
  s_add_u32 m0, s13, 0
  s_nop 0
  buffer_load_dwordx4 v5, s[48:51], s12 offen lds
  s_add_u32 s12, s12, 128
  s_add_u32 m0, s13, 2048
  s_nop 0
  buffer_load_dwordx4 v5, s[48:51], s12 offen lds
  s_add_u32 s12, s12, 128
  s_add_u32 m0, s13, 4096
  s_nop 0
  buffer_load_dwordx4 v5, s[48:51], s12 offen lds
  s_add_u32 s12, s12, 128
  s_add_u32 m0, s13, 6144
  s_nop 0
  buffer_load_dwordx4 v5, s[48:51], s12 offen lds
  s_add_u32 m0, s15, s70
  s_nop 0
  buffer_load_dwordx4 v6, s[52:55], s70 offen lds
  s_add_u32 s70, s70, 4096
  s_cmp_eq_u32 s70, 28672
  s_cselect_b32 s70, 0, s70
  s_add_u32 m0, s15, s70
  s_nop 0
  buffer_load_dwordx4 v6, s[52:55], s70 offen lds
  s_add_u32 s70, s70, 4096
  s_cmp_eq_u32 s70, 28672
  s_cselect_b32 s70, 0, s70
  s_add_u32 m0, s15, s70
  s_nop 0
  buffer_load_dwordx4 v6, s[52:55], s70 offen lds
  s_add_u32 s70, s70, 4096
  s_cmp_eq_u32 s70, 28672
  s_cselect_b32 s70, 0, s70
  s_add_u32 m0, s15, s70
  s_nop 0
  buffer_load_dwordx4 v6, s[52:55], s70 offen lds
  s_add_u32 s70, s70, 4096
  s_cmp_eq_u32 s70, 28672
  s_cselect_b32 s70, 0, s70
  s_add_u32 m0, s15, s70
  s_nop 0
  buffer_load_dwordx4 v6, s[52:55], s70 offen lds
  s_add_u32 s70, s70, 4096
  s_cmp_eq_u32 s70, 28672
  s_cselect_b32 s70, 0, s70
  s_add_u32 m0, s15, s70
  s_nop 0
  buffer_load_dwordx4 v6, s[52:55], s70 offen lds
  s_add_u32 s70, s70, 4096
  s_cmp_eq_u32 s70, 28672
  s_cselect_b32 s70, 0, s70
  s_add_u32 m0, s15, s70
  s_nop 0
  buffer_load_dwordx4 v6, s[52:55], s70 offen lds
L_ih_39:
  s_waitcnt vmcnt(0)
  s_barrier
  s_cmp_ge_u32 s3, 2
  s_cbranch_scc1 L_kvb_43
  ds_read_b128 v[56:59], v10 offset:0
  ds_read_b64_tr_b16 v[60:61], v12 offset:0
  ds_read_b64_tr_b16 v[62:63], v12 offset:224
  ds_read_b128 v[64:67], v11 offset:0
  ds_read_b64_tr_b16 v[68:69], v12 offset:1792
  ds_read_b64_tr_b16 v[70:71], v12 offset:2016
  ds_read_b128 v[72:75], v10 offset:2048
  ds_read_b64_tr_b16 v[76:77], v12 offset:3584
  ds_read_b64_tr_b16 v[78:79], v12 offset:3808
  ds_read_b128 v[80:83], v11 offset:2048
  ds_read_b64_tr_b16 v[84:85], v12 offset:5376
  ds_read_b64_tr_b16 v[86:87], v12 offset:5600
  s_bitcmp1_b32 s6, 0
  s_cbranch_scc1 L_kvV_45
  ds_read_b128 v[88:91], v10 offset:4096
  ds_read_b64_tr_b16 v[92:93], v12 offset:7168
  ds_read_b64_tr_b16 v[94:95], v12 offset:7392
  s_waitcnt lgkmcnt(12)
  v_mfma_f32_16x16x32_bf16 v[100:103], v[60:63], v[56:59], 0
  ds_read_b128 v[56:59], v11 offset:4096
  ds_read_b64_tr_b16 v[60:61], v12 offset:8960
  ds_read_b64_tr_b16 v[62:63], v12 offset:9184
  s_waitcnt lgkmcnt(12)
  v_mfma_f32_16x16x32_bf16 v[100:103], v[68:71], v[64:67], v[100:103]
  ds_read_b128 v[64:67], v10 offset:6144
  ds_read_b64_tr_b16 v[68:69], v12 offset:10752
  ds_read_b64_tr_b16 v[70:71], v12 offset:10976
  s_waitcnt lgkmcnt(12)
  v_mfma_f32_16x16x32_bf16 v[100:103], v[76:79], v[72:75], v[100:103]
  ds_read_b128 v[72:75], v11 offset:6144
  ds_read_b64_tr_b16 v[76:77], v12 offset:12544
  ds_read_b64_tr_b16 v[78:79], v12 offset:12768
  s_waitcnt lgkmcnt(12)
  v_mfma_f32_16x16x32_bf16 v[100:103], v[84:87], v[80:83], v[100:103]
  ds_read_b128 v[80:83], v10 offset:8192
  ds_read_b64_tr_b16 v[84:85], v12 offset:14336
  ds_read_b64_tr_b16 v[86:87], v12 offset:14560
  s_waitcnt lgkmcnt(12)
  v_mfma_f32_16x16x32_bf16 v[100:103], v[92:95], v[88:91], v[100:103]
  ds_read_b128 v[88:91], v11 offset:8192
  ds_read_b64_tr_b16 v[92:93], v12 offset:16128
  ds_read_b64_tr_b16 v[94:95], v12 offset:16352
  s_waitcnt lgkmcnt(12)
  v_mfma_f32_16x16x32_bf16 v[100:103], v[60:63], v[56:59], v[100:103]
  ds_read_b128 v[56:59], v10 offset:10240
  ds_read_b64_tr_b16 v[60:61], v12 offset:17920
  ds_read_b64_tr_b16 v[62:63], v12 offset:18144
  s_waitcnt lgkmcnt(12)
  v_mfma_f32_16x16x32_bf16 v[100:103], v[68:71], v[64:67], v[100:103]
  ds_read_b128 v[64:67], v11 offset:10240
  ds_read_b64_tr_b16 v[68:69], v12 offset:19712
  ds_read_b64_tr_b16 v[70:71], v12 offset:19936
  s_waitcnt lgkmcnt(12)
  v_mfma_f32_16x16x32_bf16 v[100:103], v[76:79], v[72:75], v[100:103]
  ds_read_b128 v[72:75], v10 offset:12288
  ds_read_b64_tr_b16 v[76:77], v12 offset:21504
  ds_read_b64_tr_b16 v[78:79], v12 offset:21728
  s_waitcnt lgkmcnt(12)
  v_mfma_f32_16x16x32_bf16 v[100:103], v[84:87], v[80:83], v[100:103]
  ds_read_b128 v[80:83], v11 offset:12288
  ds_read_b64_tr_b16 v[84:85], v12 offset:23296
  ds_read_b64_tr_b16 v[86:87], v12 offset:23520
  s_waitcnt lgkmcnt(12)
  v_mfma_f32_16x16x32_bf16 v[100:103], v[92:95], v[88:91], v[100:103]
  s_waitcnt lgkmcnt(9)
  v_mfma_f32_16x16x32_bf16 v[100:103], v[60:63], v[56:59], v[100:103]
  s_waitcnt lgkmcnt(6)
  v_mfma_f32_16x16x32_bf16 v[100:103], v[68:71], v[64:67], v[100:103]
  s_waitcnt lgkmcnt(3)
  v_mfma_f32_16x16x32_bf16 v[100:103], v[76:79], v[72:75], v[100:103]
  s_waitcnt lgkmcnt(0)
  v_mfma_f32_16x16x32_bf16 v[100:103], v[84:87], v[80:83], v[100:103]
  s_cmp_eq_u32 s3, 1
  s_cselect_b32 s12, 0xffff0000, 0
  s_nop 5
  v_mul_f32 v100, 0x3e8b97f6, v100
  v_mul_f32 v101, 0x3e8b97f6, v101
  v_mul_f32 v102, 0x3e8b97f6, v102
  v_mul_f32 v103, 0x3e8b97f6, v103
  v_cvt_pk_bf16_f32 v96, v100, v101
  v_cvt_pk_bf16_f32 v97, v102, v103
  s_mov_b32 exec_lo, 0
  s_mov_b32 exec_hi, s12
  v_mov_b32 v96, 0x3f803f80
  v_mov_b32 v97, 0x00003f80
  s_mov_b64 exec, -1
  s_branch L_kvst_46
L_kvV_45:
  ds_read_b128 v[88:91], v10 offset:4096
  ds_read_b64_tr_b16 v[92:93], v12 offset:7168
  ds_read_b64_tr_b16 v[94:95], v12 offset:7392
  s_waitcnt lgkmcnt(12)
  v_mfma_f32_16x16x32_bf16 v[100:103], v[56:59], v[60:63], 0
  ds_read_b128 v[56:59], v11 offset:4096
  ds_read_b64_tr_b16 v[60:61], v12 offset:8960
  ds_read_b64_tr_b16 v[62:63], v12 offset:9184
  s_waitcnt lgkmcnt(12)
  v_mfma_f32_16x16x32_bf16 v[100:103], v[64:67], v[68:71], v[100:103]
  ds_read_b128 v[64:67], v10 offset:6144
  ds_read_b64_tr_b16 v[68:69], v12 offset:10752
  ds_read_b64_tr_b16 v[70:71], v12 offset:10976
  s_waitcnt lgkmcnt(12)
  v_mfma_f32_16x16x32_bf16 v[100:103], v[72:75], v[76:79], v[100:103]
  ds_read_b128 v[72:75], v11 offset:6144
  ds_read_b64_tr_b16 v[76:77], v12 offset:12544
  ds_read_b64_tr_b16 v[78:79], v12 offset:12768
  s_waitcnt lgkmcnt(12)
  v_mfma_f32_16x16x32_bf16 v[100:103], v[80:83], v[84:87], v[100:103]
  ds_read_b128 v[80:83], v10 offset:8192
  ds_read_b64_tr_b16 v[84:85], v12 offset:14336
  ds_read_b64_tr_b16 v[86:87], v12 offset:14560
  s_waitcnt lgkmcnt(12)
  v_mfma_f32_16x16x32_bf16 v[100:103], v[88:91], v[92:95], v[100:103]
  ds_read_b128 v[88:91], v11 offset:8192
  ds_read_b64_tr_b16 v[92:93], v12 offset:16128
  ds_read_b64_tr_b16 v[94:95], v12 offset:16352
  s_waitcnt lgkmcnt(12)
  v_mfma_f32_16x16x32_bf16 v[100:103], v[56:59], v[60:63], v[100:103]
  ds_read_b128 v[56:59], v10 offset:10240
  ds_read_b64_tr_b16 v[60:61], v12 offset:17920
  ds_read_b64_tr_b16 v[62:63], v12 offset:18144
  s_waitcnt lgkmcnt(12)
  v_mfma_f32_16x16x32_bf16 v[100:103], v[64:67], v[68:71], v[100:103]
  ds_read_b128 v[64:67], v11 offset:10240
  ds_read_b64_tr_b16 v[68:69], v12 offset:19712
  ds_read_b64_tr_b16 v[70:71], v12 offset:19936
  s_waitcnt lgkmcnt(12)
  v_mfma_f32_16x16x32_bf16 v[100:103], v[72:75], v[76:79], v[100:103]
  ds_read_b128 v[72:75], v10 offset:12288
  ds_read_b64_tr_b16 v[76:77], v12 offset:21504
  ds_read_b64_tr_b16 v[78:79], v12 offset:21728
  s_waitcnt lgkmcnt(12)
  v_mfma_f32_16x16x32_bf16 v[100:103], v[80:83], v[84:87], v[100:103]
  ds_read_b128 v[80:83], v11 offset:12288
  ds_read_b64_tr_b16 v[84:85], v12 offset:23296
  ds_read_b64_tr_b16 v[86:87], v12 offset:23520
  s_waitcnt lgkmcnt(12)
  v_mfma_f32_16x16x32_bf16 v[100:103], v[88:91], v[92:95], v[100:103]
  s_waitcnt lgkmcnt(9)
  v_mfma_f32_16x16x32_bf16 v[100:103], v[56:59], v[60:63], v[100:103]
  s_waitcnt lgkmcnt(6)
  v_mfma_f32_16x16x32_bf16 v[100:103], v[64:67], v[68:71], v[100:103]
  s_waitcnt lgkmcnt(3)
  v_mfma_f32_16x16x32_bf16 v[100:103], v[72:75], v[76:79], v[100:103]
  s_waitcnt lgkmcnt(0)
  v_mfma_f32_16x16x32_bf16 v[100:103], v[80:83], v[84:87], v[100:103]
  s_cmp_eq_u32 s3, 1
  s_cselect_b32 s12, 0xe000e000, 0
  s_cselect_b32 s13, 0x10001000, 0
  s_nop 4
  v_cvt_pk_bf16_f32 v96, v100, v101
  v_cvt_pk_bf16_f32 v97, v102, v103
  s_mov_b32 exec_lo, s12
  s_mov_b32 exec_hi, s12
  v_mov_b32 v96, 0
  v_mov_b32 v97, 0
  s_mov_b32 exec_lo, s13
  s_mov_b32 exec_hi, s13
  v_mov_b32 v96, 0x3f803f80
  v_mov_b32 v97, 0x3f803f80
  s_mov_b64 exec, -1
L_kvst_46:
  s_nop 1
  v_permlane32_swap_b32 v96, v98
  v_permlane32_swap_b32 v97, v99
  s_mov_b32 exec_hi, 0
  buffer_store_dwordx4 v[96:99], v13, s[56:59], s69 offen sc1
  s_mov_b32 exec_hi, -1
L_kvb_43:
  v_mov_b32 v33, s46
  s_waitcnt vmcnt(0)
  s_barrier
  s_cmp_lg_u32 s3, 0
  s_cbranch_scc1 L_kvf_44
  s_mov_b64 exec, 0xffffffff
  buffer_store_dword v33, v14, s[56:59], s68 offen sc1
  s_mov_b64 exec, -1
L_kvf_44:
  s_lshl_b32 s8, s2, 8
  s_add_u32 s8, s8, 327680
  s_mov_b32 s40, s46
  s_mov_b32 s41, s46
  s_mov_b32 s47, 1048576
L_sp_47:
  s_load_dword s16, s[44:45], s8 glc
  s_waitcnt lgkmcnt(0)
  s_cmp_eq_u32 s16, s46
  s_cbranch_scc1 L_spd_49
L_spr_48:
  s_sleep 1
  s_sub_u32 s47, s47, 1
  s_cmp_gt_i32 s47, 0
  s_cbranch_scc1 L_sp_47
L_spd_49:
  s_lshl_b32 s8, s4, 2
  s_and_b32 s12, s5, 3
  s_add_u32 s8, s8, s12
  s_mul_i32 s8, s8, 12544
  s_lshl_b32 s12, s3, 10
  s_add_u32 s8, s8, s12
  buffer_load_dwordx4 v[240:243], v15, s[64:67], s8 offen
  s_add_u32 s8, s8, 4096
  buffer_load_dwordx4 v[240:243], v15, s[64:67], s8 offen
  s_add_u32 s8, s8, 4096
  buffer_load_dwordx4 v[240:243], v15, s[64:67], s8 offen
  s_add_u32 s8, s8, 4096
  buffer_load_dwordx4 v[240:243], v15, s[64:67], s8 offen
  s_cmp_lg_u32 s2, 253
  s_cbranch_scc1 L_eu_50
  v_lshlrev_b32 v2, 8, v0
  s_lshl_b32 s8, s3, 14
  s_add_u32 s8, s8, 327680
  s_mov_b32 exec_lo, 0xffffffff
  s_mov_b32 exec_hi, 0xffffffff
  s_mov_b32 s47, 1048576
L_poll_51:
  buffer_load_dword v250, v2, s[56:59], s8 offen sc1
  s_waitcnt vmcnt(0)
  v_xor_b32 v250, s46, v250
  v_cmp_ne_u32 vcc, 0, v250
  s_nop 0
  s_cbranch_vccz L_polled_52
  s_sleep 16
  s_sub_u32 s47, s47, 1
  s_cmp_lg_u32 s47, 0
  s_cbranch_scc1 L_poll_51
L_polled_52:
  s_mov_b64 exec, -1
  v_lshrrev_b32 v2, 3, v0
  v_lshlrev_b32 v2, 7, v2
  v_and_b32 v3, 7, v0
  v_lshl_add_u32 v2, v3, 2, v2
  s_lshl_b32 s8, s3, 10
  s_add_u32 s8, s8, 524288
  s_mov_b32 exec_lo, 0xffffffff
  s_mov_b32 exec_hi, 0xffffffff
  s_mov_b32 s47, 1048576
L_poll_53:
  buffer_load_dword v250, v2, s[56:59], s8 offen sc1
  s_waitcnt vmcnt(0)
  v_xor_b32 v250, s46, v250
  v_cmp_ne_u32 vcc, 0, v250
  s_nop 0
  s_cbranch_vccz L_polled_54
  s_sleep 16
  s_sub_u32 s47, s47, 1
  s_cmp_lg_u32 s47, 0
  s_cbranch_scc1 L_poll_53
L_polled_54:
  s_mov_b64 exec, -1
  s_barrier
  s_cmp_lg_u32 s3, 0
  s_cbranch_scc1 L_eu_50
  v_mov_b32 v2, 0
  v_mov_b32 v3, s46
  s_mov_b64 exec, 1
  buffer_store_dword v3, v2, s[56:59], 0 offen sc1
L_eu_50:
  s_endpgm
L_roleA_1:
  s_setprio 3
  s_lshr_b32 s8, s5, 3
  s_lshl_b32 s6, s4, 2
  s_add_u32 s6, s6, s8
  s_and_b32 s7, s5, 7
  s_lshl_b32 s8, s3, 4
  s_lshl_b32 s9, s6, 6
  s_add_u32 s9, s9, s8
  s_mul_i32 s9, s9, 896
  v_lshrrev_b32 v2, 3, v0
  v_lshrrev_b32 v3, 4, v0
  v_and_b32 v4, 7, v0
  v_xor_b32 v4, v4, v3
  v_mul_u32_u24 v2, 896, v2
  v_lshl_add_u32 v112, v4, 4, v2
  v_add_u32 v112, s9, v112
  v_xor_b32 v4, 4, v4
  v_lshl_add_u32 v113, v4, 4, v2
  v_add_u32 v113, s9, v113
  v_add_u32 v113, 7168, v113
  s_lshl_b32 s10, s3, 11
  s_lshl_b32 s8, s3, 4
  s_mul_i32 s9, s8, 896
  s_mul_i32 s11, s7, 112
  s_add_u32 s9, s9, s11
  v_lshrrev_b32 v2, 3, v0
  v_mul_u32_u24 v2, 896, v2
  v_bfe_u32 v3, v0, 4, 1
  v_lshlrev_b32 v3, 2, v3
  v_and_b32 v4, 7, v0
  v_xor_b32 v3, v3, v4
  v_lshl_add_u32 v114, v3, 4, v2
  v_add_u32 v114, s9, v114
  v_add_u32 v115, 7168, v114
  s_lshr_b32 s8, s5, 3
  s_lshl_b32 s8, s8, 1
  s_add_u32 s8, s8, s7
  s_cmp_ge_u32 s8, 7
  s_cselect_b32 s9, 7, 0
  s_sub_u32 s8, s8, s9
  s_cmp_ge_u32 s8, 7
  s_cselect_b32 s9, 7, 0
  s_sub_u32 s8, s8, s9
  s_lshl_b32 s14, s8, 7
  s_mul_i32 s15, s8, 57344
  s_waitcnt lgkmcnt(0)
  s_mov_b32 s56, s44
  s_mov_b32 s57, s45
  s_mov_b32 s58, 0x800000
  s_mov_b32 s59, 0x20000
  buffer_load_dword v54, off, s[56:59], 0 offset:0 sc1
  s_mov_b32 s48, s30
  s_mov_b32 s49, s31
  s_mov_b32 s50, 0x1c0000
  s_mov_b32 s51, 0x20000
  s_mov_b32 s52, s32
  s_mov_b32 s53, s33
  s_mov_b32 s54, 0x62000
  s_mov_b32 s55, 0x20000
  s_setprio 1
  s_add_u32 m0, s10, 0
  s_nop 0
  buffer_load_dwordx4 v112, s[48:51], s14 offen lds
  s_add_u32 m0, s10, 1024
  s_nop 0
  buffer_load_dwordx4 v113, s[48:51], s14 offen lds
  s_add_u32 s14, s14, 128
  s_cmp_eq_u32 s14, 896
  s_cselect_b32 s14, 0, s14
  s_add_u32 m0, s10, 8192
  s_nop 0
  buffer_load_dwordx4 v114, s[52:55], s15 offen lds
  s_add_u32 m0, s10, 9216
  s_nop 0
  buffer_load_dwordx4 v115, s[52:55], s15 offen lds
  s_add_u32 s15, s15, 57344
  s_cmp_eq_u32 s15, 401408
  s_cselect_b32 s15, 0, s15
  s_add_u32 m0, s10, 16384
  s_nop 0
  buffer_load_dwordx4 v112, s[48:51], s14 offen lds
  s_add_u32 m0, s10, 17408
  s_nop 0
  buffer_load_dwordx4 v113, s[48:51], s14 offen lds
  s_add_u32 s14, s14, 128
  s_cmp_eq_u32 s14, 896
  s_cselect_b32 s14, 0, s14
  s_add_u32 m0, s10, 24576
  s_nop 0
  buffer_load_dwordx4 v114, s[52:55], s15 offen lds
  s_add_u32 m0, s10, 25600
  s_nop 0
  buffer_load_dwordx4 v115, s[52:55], s15 offen lds
  s_add_u32 s15, s15, 57344
  s_cmp_eq_u32 s15, 401408
  s_cselect_b32 s15, 0, s15
  s_mov_b32 s64, s38
  s_mov_b32 s65, s39
  s_mov_b32 s66, 0x62000
  s_mov_b32 s67, 0x20000
  s_mov_b32 s60, s40
  s_mov_b32 s61, s41
  s_mov_b32 s62, 0x380000
  s_mov_b32 s63, 0x20000
  s_and_b32 s8, s3, 1
  s_lshl_b32 s8, s8, 5
  v_and_b32 v2, 31, v0
  v_add_u32 v2, s8, v2
  v_bfe_u32 v3, v2, 1, 3
  v_lshrrev_b32 v4, 5, v0
  v_xor_b32 v3, v3, v4
  v_lshlrev_b32 v2, 7, v2
  v_xor_b32 v9, 0, v3
  v_lshl_add_u32 v116, v9, 4, v2
  v_add_u32 v121, 0x10000, v116
  v_xor_b32 v9, 2, v3
  v_lshl_add_u32 v117, v9, 4, v2
  v_add_u32 v122, 0x10000, v117
  v_xor_b32 v9, 4, v3
  v_lshl_add_u32 v118, v9, 4, v2
  v_add_u32 v123, 0x10000, v118
  v_xor_b32 v9, 6, v3
  v_lshl_add_u32 v119, v9, 4, v2
  v_add_u32 v124, 0x10000, v119
  s_lshr_b32 s8, s3, 1
  s_mul_i32 s8, s8, 56
  v_bfe_u32 v2, v0, 4, 1
  v_lshlrev_b32 v2, 5, v2
  v_and_b32 v3, 3, v0
  v_lshl_add_u32 v2, v3, 3, v2
  v_add_u32 v2, s8, v2
  v_bfe_u32 v3, v0, 3, 1
  v_lshlrev_b32 v3, 6, v3
  v_xor_b32 v2, v2, v3
  v_lshrrev_b32 v3, 5, v0
  v_mul_u32_u24 v3, 8, v3
  v_bfe_u32 v4, v0, 2, 2
  v_add_u32 v3, v3, v4
  v_lshl_add_u32 v120, v3, 7, v2
  v_add_u32 v125, 0x10000, v120
  v_lshlrev_b32 v15, 4, v0
  s_lshl_b32 s8, s3, 11
  s_add_u32 s8, s8, 32768
  v_add_u32 v126, s8, v15
  s_add_u32 s8, s3, 1
  s_and_b32 s8, s8, 3
  s_lshl_b32 s9, s8, 11
  s_add_u32 s9, s9, 32768
  v_add_u32 v192, s9, v15
  s_mul_i32 s9, s8, 12288
  v_add_u32 v196, s9, v15
  s_add_u32 s8, s3, 2
  s_and_b32 s8, s8, 3
  s_lshl_b32 s9, s8, 11
  s_add_u32 s9, s9, 32768
  v_add_u32 v193, s9, v15
  s_mul_i32 s9, s8, 12288
  v_add_u32 v197, s9, v15
  s_add_u32 s8, s3, 3
  s_and_b32 s8, s8, 3
  s_lshl_b32 s9, s8, 11
  s_add_u32 s9, s9, 32768
  v_add_u32 v194, s9, v15
  s_mul_i32 s9, s8, 12288
  v_add_u32 v198, s9, v15
  s_add_u32 s8, s3, 4
  s_and_b32 s8, s8, 3
  s_lshl_b32 s9, s8, 11
  s_add_u32 s9, s9, 32768
  v_add_u32 v195, s9, v15
  v_mov_b32 v64, 0
  v_mov_b32 v65, 0
  v_mov_b32 v66, 0
  v_mov_b32 v67, 0
  v_mov_b32 v68, 0
  v_mov_b32 v69, 0
  v_mov_b32 v70, 0
  v_mov_b32 v71, 0
  v_mov_b32 v72, 0
  v_mov_b32 v73, 0
  v_mov_b32 v74, 0
  v_mov_b32 v75, 0
  v_mov_b32 v76, 0
  v_mov_b32 v77, 0
  v_mov_b32 v78, 0
  v_mov_b32 v79, 0
  v_mov_b32 v80, 0
  v_mov_b32 v81, 0
  v_mov_b32 v82, 0
  v_mov_b32 v83, 0
  v_mov_b32 v84, 0
  v_mov_b32 v85, 0
  v_mov_b32 v86, 0
  v_mov_b32 v87, 0
  v_mov_b32 v88, 0
  v_mov_b32 v89, 0
  v_mov_b32 v90, 0
  v_mov_b32 v91, 0
  v_mov_b32 v92, 0
  v_mov_b32 v93, 0
  v_mov_b32 v94, 0
  v_mov_b32 v95, 0
  v_mov_b32 v96, 0
  v_mov_b32 v97, 0
  v_mov_b32 v98, 0
  v_mov_b32 v99, 0
  v_mov_b32 v100, 0
  v_mov_b32 v101, 0
  v_mov_b32 v102, 0
  v_mov_b32 v103, 0
  v_mov_b32 v104, 0
  v_mov_b32 v105, 0
  v_mov_b32 v106, 0
  v_mov_b32 v107, 0
  v_mov_b32 v108, 0
  v_mov_b32 v109, 0
  v_mov_b32 v110, 0
  v_mov_b32 v111, 0
  s_lshl_b32 s8, s3, 13
  s_add_u32 s8, s8, 65536
  s_mov_b32 s37, s8
  s_add_u32 s9, s5, 0
  s_and_b32 s12, s9, 1
  s_lshl_b32 s12, s12, 12
  s_and_b32 s9, s9, 2
  s_lshl_b32 s9, s9, 14
  s_add_u32 s9, s9, s12
  s_add_u32 s32, s8, s9
  s_add_u32 s9, s5, 1
  s_and_b32 s12, s9, 1
  s_lshl_b32 s12, s12, 12
  s_and_b32 s9, s9, 2
  s_lshl_b32 s9, s9, 14
  s_add_u32 s9, s9, s12
  s_add_u32 s33, s8, s9
  s_add_u32 s9, s5, 2
  s_and_b32 s12, s9, 1
  s_lshl_b32 s12, s12, 12
  s_and_b32 s9, s9, 2
  s_lshl_b32 s9, s9, 14
  s_add_u32 s9, s9, s12
  s_add_u32 s34, s8, s9
  s_add_u32 s9, s5, 3
  s_and_b32 s12, s9, 1
  s_lshl_b32 s12, s12, 12
  s_and_b32 s9, s9, 2
  s_lshl_b32 s9, s9, 14
  s_add_u32 s9, s9, s12
  s_add_u32 s35, s8, s9
  s_and_b32 s36, s2, 31
  s_lshl_b32 s36, s36, 12
  s_lshl_b32 s8, s3, 7
  s_add_u32 s36, s36, s8
  s_add_u32 s36, s36, 524288
  s_mov_b32 s38, 0x07060302
  s_and_b32 s69, s2, 255
  s_lshl_b32 s69, s69, 8
  s_add_u32 s69, s69, 327680
  v_mov_b32 v248, 0
  s_lshl_b32 s71, s3, 10
  s_mul_i32 s8, s3, 7168
  s_lshl_b32 s9, s7, 4
  s_sub_u32 s8, s9, s8
  v_add_u32 v249, s8, v114
  s_cmp_eq_u32 s7, 7
  s_cselect_b32 s66, 0, s66
  s_mov_b32 s72, 0
  s_mov_b32 s73, 0
  s_mov_b32 s75, 0
  s_lshr_b32 s12, s3, 1
  s_and_b32 s13, s3, 1
  s_lshl_b32 s8, s6, 1
  s_add_u32 s8, s8, s13
  s_lshl_b32 s39, s8, 15
  s_add_u32 s39, s39, 1048576
  s_lshl_b32 s9, s7, 1
  s_add_u32 s9, s9, s12
  s_lshl_b32 s9, s9, 11
  s_add_u32 s42, s39, s9
  s_lshl_b32 s8, s6, 12
  s_add_u32 s8, s8, 786432
  s_lshr_b32 s9, s7, 2
  s_and_b32 s11, s7, 3
  s_cmp_eq_u32 s9, s12
  s_cselect_b32 s101, s11, 9
  s_lshl_b32 s9, s9, 1
  s_add_u32 s9, s9, s13
  s_lshl_b32 s9, s9, 7
  s_add_u32 s9, s9, s8
  v_lshl_add_u32 v7, v0, 9, s9
  s_lshl_b32 s9, s7, 2
  s_add_u32 s9, s9, s3
  s_lshl_b32 s9, s9, 7
  s_add_u32 s100, s8, s9
  s_lshl_b32 s9, s11, 1
  s_add_u32 s9, s9, s12
  s_lshl_b32 s43, s9, 2
  s_lshl_b32 s8, s12, 6
  v_bfe_u32 v2, v0, 4, 1
  v_lshlrev_b32 v2, 5, v2
  v_and_b32 v3, 3, v0
  v_lshl_add_u32 v2, v3, 3, v2
  v_add_u32 v2, s8, v2
  v_bfe_u32 v3, v0, 3, 1
  v_lshlrev_b32 v3, 6, v3
  v_xor_b32 v2, v2, v3
  v_lshrrev_b32 v3, 5, v0
  v_mul_u32_u24 v3, 4, v3
  v_bfe_u32 v4, v0, 2, 2
  v_add_u32 v3, v3, v4
  v_lshl_add_u32 v14, v3, 7, v2
  s_and_b32 s9, s7, 1
  s_lshl_b32 s11, s12, 1
  s_add_u32 s11, s11, s9
  s_xor_b32 s9, s11, 1
  s_lshl_b32 s96, s11, 13
  s_lshl_b32 s97, s9, 13
  s_add_u32 s96, s96, s39
  s_add_u32 s97, s97, s39
  s_mul_i32 s8, s11, 14336
  s_mul_i32 s9, s9, 14336
  s_add_u32 s8, s8, 23552
  s_add_u32 s9, s9, 23552
  v_add_u32 v12, s9, v14
  v_add_u32 v14, s8, v14
  v_xor_b32 v13, 64, v14
  v_xor_b32 v11, 64, v12
  s_xor_b32 s9, s3, 2
  s_lshl_b32 s9, s9, 12
  v_add_u32 v5, s9, v15
  s_lshl_b32 s9, s3, 12
  v_add_u32 v6, s9, v15
  s_mul_i32 s9, s13, 4608
  s_lshl_b32 s11, s12, 6
  s_add_u32 s9, s9, s11
  s_add_u32 s9, s9, 16384
  v_lshrrev_b32 v4, 5, v0
  v_and_b32 v9, 31, v0
  v_mul_u32_u24 v9, 144, v9
  v_lshl_add_u32 v9, v4, 4, v9
  v_add_u32 v9, s9, v9
  v_lshrrev_b32 v2, 3, v0
  v_and_b32 v3, 7, v0
  v_lshlrev_b32 v3, 4, v3
  v_mul_u32_u24 v10, 144, v2
  s_mul_i32 s9, s3, 2304
  s_add_u32 s9, s9, 16384
  v_add3_u32 v10, v10, v3, s9
  v_mul_u32_u24 v8, 1792, v2
  v_add_u32 v8, v8, v3
  s_lshl_b32 s8, s6, 2
  s_add_u32 s8, s8, s3
  s_mul_i32 s8, s8, 28672
  s_lshl_b32 s9, s7, 7
  s_add_u32 s8, s8, s9
  s_add_u32 s98, s8, 896
  s_add_u32 s99, s98, 14336
  v_add_u32 v1, s71, v15
  s_mul_i32 s8, s3, 12288
  v_add_u32 v2, s8, v15
  s_lshl_b32 s8, s3, 4
  v_mov_b32 v4, s8
  s_add_u32 m0, s10, 40960
  s_nop 0
  buffer_load_dwordx4 v114, s[52:55], s15 offen lds
  s_add_u32 m0, s10, 41984
  s_nop 0
  buffer_load_dwordx4 v115, s[52:55], s15 offen lds
  s_add_u32 s15, s15, 57344
  s_cmp_eq_u32 s15, 401408
  s_cselect_b32 s15, 0, s15
  s_add_u32 m0, s10, 32768
  s_nop 0
  buffer_load_dwordx4 v112, s[48:51], s14 offen lds
  s_add_u32 m0, s10, 33792
  s_nop 0
  buffer_load_dwordx4 v113, s[48:51], s14 offen lds
  s_add_u32 s14, s14, 128
  s_cmp_eq_u32 s14, 896
  s_cselect_b32 s14, 0, s14
  s_add_u32 m0, s10, 57344
  s_nop 0
  buffer_load_dwordx4 v114, s[52:55], s15 offen lds
  s_add_u32 m0, s10, 58368
  s_nop 0
  buffer_load_dwordx4 v115, s[52:55], s15 offen lds
  s_add_u32 s15, s15, 57344
  s_cmp_eq_u32 s15, 401408
  s_cselect_b32 s15, 0, s15
  s_add_u32 m0, s10, 49152
  s_nop 0
  buffer_load_dwordx4 v112, s[48:51], s14 offen lds
  s_add_u32 m0, s10, 50176
  s_nop 0
  buffer_load_dwordx4 v113, s[48:51], s14 offen lds
  s_add_u32 s14, s14, 128
  s_cmp_eq_u32 s14, 896
  s_cselect_b32 s14, 0, s14
  s_setprio 3
  s_waitcnt vmcnt(12) lgkmcnt(0)
  s_barrier
  ds_read_b128 v[144:147], v116 offset:0
  ds_read_b64_tr_b16 v[160:161], v120 offset:8192
  ds_read_b64_tr_b16 v[162:163], v120 offset:8704
  ds_read_b128 v[148:151], v117 offset:0
  ds_read_b64_tr_b16 v[164:165], v120 offset:10240
  ds_read_b64_tr_b16 v[166:167], v120 offset:10752
  ds_read_b128 v[152:155], v118 offset:0
  ds_read_b64_tr_b16 v[168:169], v120 offset:12288
  ds_read_b64_tr_b16 v[170:171], v120 offset:12800
  ds_read_b128 v[156:159], v119 offset:0
  ds_read_b64_tr_b16 v[172:173], v120 offset:14336
  ds_read_b64_tr_b16 v[174:175], v120 offset:14848
  s_add_u32 m0, s10, 73728
  s_nop 0
  buffer_load_dwordx4 v114, s[52:55], s15 offen lds
  s_add_u32 m0, s10, 74752
  s_nop 0
  buffer_load_dwordx4 v115, s[52:55], s15 offen lds
  s_add_u32 s15, s15, 57344
  s_cmp_eq_u32 s15, 401408
  s_cselect_b32 s15, 0, s15
  s_add_u32 m0, s10, 65536
  s_nop 0
  buffer_load_dwordx4 v112, s[48:51], s14 offen lds
  s_add_u32 m0, s10, 66560
  s_nop 0
  buffer_load_dwordx4 v113, s[48:51], s14 offen lds
  s_add_u32 s14, s14, 128
  s_cmp_eq_u32 s14, 896
  s_cselect_b32 s14, 0, s14
  v_readfirstlane_b32 s46, v54
  s_nop 0
  s_add_u32 s46, s46, 0x9e3779b9
  s_mov_b32 s40, s46
  s_mov_b32 s41, s46
  v_mov_b32 v199, s46
  s_waitcnt vmcnt(12) lgkmcnt(0)
  s_barrier
  ds_read_b128 v[176:179], v116 offset:16384
  ds_read_b64_tr_b16 v[232:233], v120 offset:24576
  ds_read_b64_tr_b16 v[234:235], v120 offset:25088
  ds_read_b128 v[180:183], v117 offset:16384
  ds_read_b64_tr_b16 v[236:237], v120 offset:26624
  ds_read_b64_tr_b16 v[238:239], v120 offset:27136
  ds_read_b128 v[184:187], v118 offset:16384
  ds_read_b64_tr_b16 v[240:241], v120 offset:28672
  ds_read_b64_tr_b16 v[242:243], v120 offset:29184
  ds_read_b128 v[188:191], v119 offset:16384
  ds_read_b64_tr_b16 v[244:245], v120 offset:30720
  ds_read_b64_tr_b16 v[246:247], v120 offset:31232
  v_mfma_f32_32x32x16_bf16 v[48:63], v[160:163], v[144:147], 0
  v_mfma_f32_32x32x16_bf16 v[48:63], v[164:167], v[148:151], v[48:63]
  v_mfma_f32_32x32x16_bf16 v[48:63], v[168:171], v[152:155], v[48:63]
  v_mfma_f32_32x32x16_bf16 v[48:63], v[172:175], v[156:159], v[48:63]
  s_add_u32 m0, s10, 8192
  s_nop 0
  buffer_load_dwordx4 v114, s[52:55], s15 offen lds
  s_add_u32 m0, s10, 9216
  s_nop 0
  buffer_load_dwordx4 v115, s[52:55], s15 offen lds
  s_add_u32 s15, s15, 57344
  s_cmp_eq_u32 s15, 401408
  s_cselect_b32 s15, 0, s15
  s_add_u32 m0, s10, 0
  s_nop 0
  buffer_load_dwordx4 v112, s[48:51], s14 offen lds
  s_add_u32 m0, s10, 1024
  s_nop 0
  buffer_load_dwordx4 v113, s[48:51], s14 offen lds
  s_add_u32 s14, s14, 128
  s_cmp_eq_u32 s14, 896
  s_cselect_b32 s14, 0, s14
  s_waitcnt vmcnt(12) lgkmcnt(0)
  s_barrier
  ds_read_b128 v[144:147], v116 offset:32768
  ds_read_b64_tr_b16 v[160:161], v120 offset:40960
  ds_read_b64_tr_b16 v[162:163], v120 offset:41472
  ds_read_b128 v[148:151], v117 offset:32768
  ds_read_b64_tr_b16 v[164:165], v120 offset:43008
  ds_read_b64_tr_b16 v[166:167], v120 offset:43520
  ds_read_b128 v[152:155], v118 offset:32768
  ds_read_b64_tr_b16 v[168:169], v120 offset:45056
  ds_read_b64_tr_b16 v[170:171], v120 offset:45568
  ds_read_b128 v[156:159], v119 offset:32768
  ds_read_b64_tr_b16 v[172:173], v120 offset:47104
  ds_read_b64_tr_b16 v[174:175], v120 offset:47616
  v_mfma_f32_32x32x16_bf16 v[48:63], v[232:235], v[176:179], v[48:63]
  v_mfma_f32_32x32x16_bf16 v[48:63], v[236:239], v[180:183], v[48:63]
  v_mfma_f32_32x32x16_bf16 v[48:63], v[240:243], v[184:187], v[48:63]
  v_mfma_f32_32x32x16_bf16 v[48:63], v[244:247], v[188:191], v[48:63]
  s_add_u32 m0, s10, 24576
  s_nop 0
  buffer_load_dwordx4 v114, s[52:55], s15 offen lds
  s_add_u32 m0, s10, 25600
  s_nop 0
  buffer_load_dwordx4 v115, s[52:55], s15 offen lds
  s_add_u32 m0, s10, 16384
  s_nop 0
  buffer_load_dwordx4 v112, s[48:51], s14 offen lds
  s_add_u32 m0, s10, 17408
  s_nop 0
  buffer_load_dwordx4 v113, s[48:51], s14 offen lds
  s_waitcnt vmcnt(12) lgkmcnt(0)
  s_barrier
  ds_read_b128 v[176:179], v116 offset:49152
  ds_read_b64_tr_b16 v[232:233], v120 offset:57344
  ds_read_b64_tr_b16 v[234:235], v120 offset:57856
  ds_read_b128 v[180:183], v117 offset:49152
  ds_read_b64_tr_b16 v[236:237], v120 offset:59392
  ds_read_b64_tr_b16 v[238:239], v120 offset:59904
  ds_read_b128 v[184:187], v118 offset:49152
  ds_read_b64_tr_b16 v[240:241], v120 offset:61440
  ds_read_b64_tr_b16 v[242:243], v120 offset:61952
  ds_read_b128 v[188:191], v119 offset:49152
  ds_read_b64_tr_b16 v[244:245], v120 offset:63488
  ds_read_b64_tr_b16 v[246:247], v120 offset:64000
  v_mfma_f32_32x32x16_bf16 v[48:63], v[160:163], v[144:147], v[48:63]
  v_mfma_f32_32x32x16_bf16 v[48:63], v[164:167], v[148:151], v[48:63]
  v_mfma_f32_32x32x16_bf16 v[48:63], v[168:171], v[152:155], v[48:63]
  v_mfma_f32_32x32x16_bf16 v[48:63], v[172:175], v[156:159], v[48:63]
  buffer_store_dword v199, v248, s[56:59], s69 offen sc1
  s_waitcnt vmcnt(9) lgkmcnt(0)
  s_barrier
  ds_read_b128 v[144:147], v121 offset:0
  ds_read_b64_tr_b16 v[160:161], v125 offset:8192
  ds_read_b64_tr_b16 v[162:163], v125 offset:8704
  ds_read_b128 v[148:151], v122 offset:0
  ds_read_b64_tr_b16 v[164:165], v125 offset:10240
  ds_read_b64_tr_b16 v[166:167], v125 offset:10752
  ds_read_b128 v[152:155], v123 offset:0
  ds_read_b64_tr_b16 v[168:169], v125 offset:12288
  ds_read_b64_tr_b16 v[170:171], v125 offset:12800
  ds_read_b128 v[156:159], v124 offset:0
  ds_read_b64_tr_b16 v[172:173], v125 offset:14336
  ds_read_b64_tr_b16 v[174:175], v125 offset:14848
  v_mfma_f32_32x32x16_bf16 v[48:63], v[232:235], v[176:179], v[48:63]
  v_mfma_f32_32x32x16_bf16 v[48:63], v[236:239], v[180:183], v[48:63]
  v_mfma_f32_32x32x16_bf16 v[48:63], v[240:243], v[184:187], v[48:63]
  v_mfma_f32_32x32x16_bf16 v[48:63], v[244:247], v[188:191], v[48:63]
  s_waitcnt vmcnt(5) lgkmcnt(0)
  s_barrier
  ds_read_b128 v[176:179], v116 offset:0
  ds_read_b64_tr_b16 v[232:233], v120 offset:8192
  ds_read_b64_tr_b16 v[234:235], v120 offset:8704
  ds_read_b128 v[180:183], v117 offset:0
  ds_read_b64_tr_b16 v[236:237], v120 offset:10240
  ds_read_b64_tr_b16 v[238:239], v120 offset:10752
  ds_read_b128 v[184:187], v118 offset:0
  ds_read_b64_tr_b16 v[240:241], v120 offset:12288
  ds_read_b64_tr_b16 v[242:243], v120 offset:12800
  ds_read_b128 v[188:191], v119 offset:0
  ds_read_b64_tr_b16 v[244:245], v120 offset:14336
  ds_read_b64_tr_b16 v[246:247], v120 offset:14848
  v_mfma_f32_32x32x16_bf16 v[48:63], v[160:163], v[144:147], v[48:63]
  v_mfma_f32_32x32x16_bf16 v[48:63], v[164:167], v[148:151], v[48:63]
  v_mfma_f32_32x32x16_bf16 v[48:63], v[168:171], v[152:155], v[48:63]
  v_mfma_f32_32x32x16_bf16 v[48:63], v[172:175], v[156:159], v[48:63]
  s_waitcnt lgkmcnt(9)
  v_mfma_f32_32x32x16_bf16 v[48:63], v[232:235], v[176:179], v[48:63]
  s_waitcnt lgkmcnt(6)
  v_mfma_f32_32x32x16_bf16 v[48:63], v[236:239], v[180:183], v[48:63]
  s_waitcnt lgkmcnt(3)
  v_mfma_f32_32x32x16_bf16 v[48:63], v[240:243], v[184:187], v[48:63]
  s_waitcnt lgkmcnt(0)
  v_mfma_f32_32x32x16_bf16 v[48:63], v[244:247], v[188:191], v[48:63]
  s_waitcnt vmcnt(1) lgkmcnt(0)
  s_barrier
  ds_read_b128 v[144:147], v116 offset:16384
  ds_read_b64_tr_b16 v[160:161], v120 offset:24576
  ds_read_b64_tr_b16 v[162:163], v120 offset:25088
  ds_read_b128 v[148:151], v117 offset:16384
  ds_read_b64_tr_b16 v[164:165], v120 offset:26624
  ds_read_b64_tr_b16 v[166:167], v120 offset:27136
  ds_read_b128 v[152:155], v118 offset:16384
  ds_read_b64_tr_b16 v[168:169], v120 offset:28672
  ds_read_b64_tr_b16 v[170:171], v120 offset:29184
  ds_read_b128 v[156:159], v119 offset:16384
  ds_read_b64_tr_b16 v[172:173], v120 offset:30720
  ds_read_b64_tr_b16 v[174:175], v120 offset:31232
  s_waitcnt lgkmcnt(9)
  v_mfma_f32_32x32x16_bf16 v[48:63], v[160:163], v[144:147], v[48:63]
  s_waitcnt lgkmcnt(6)
  v_mfma_f32_32x32x16_bf16 v[48:63], v[164:167], v[148:151], v[48:63]
  s_waitcnt lgkmcnt(3)
  v_mfma_f32_32x32x16_bf16 v[48:63], v[168:171], v[152:155], v[48:63]
  s_waitcnt lgkmcnt(0)
  v_mfma_f32_32x32x16_bf16 v[48:63], v[172:175], v[156:159], v[48:63]
  v_mov_b32 v184, 0
  v_mov_b32 v185, 0
  v_mov_b32 v186, 0
  v_mov_b32 v187, 0
  v_mov_b32 v188, 0
  v_mov_b32 v189, 0
  v_mov_b32 v190, 0
  v_mov_b32 v191, 0
  s_nop 3
  v_cvt_pk_bf16_f32 v224, v48, v49
  v_cvt_pk_bf16_f32 v225, v50, v51
  v_cvt_pk_bf16_f32 v226, v52, v53
  v_cvt_pk_bf16_f32 v227, v54, v55
  v_cvt_pk_bf16_f32 v228, v56, v57
  v_cvt_pk_bf16_f32 v229, v58, v59
  v_cvt_pk_bf16_f32 v230, v60, v61
  v_cvt_pk_bf16_f32 v231, v62, v63
  s_mov_b32 exec_lo, 0
  v_mov_b32 v230, 0
  v_mov_b32 v231, 0
  s_mov_b32 exec_lo, -1
  ds_write_b128 v126, v[224:227]
  ds_write_b128 v126, v[228:231] offset:1024
  v_mov_b32 v48, 0
  v_mov_b32 v49, 0
  v_mov_b32 v50, 0
  v_mov_b32 v51, 0
  v_mov_b32 v52, 0
  v_mov_b32 v53, 0
  v_mov_b32 v54, 0
  v_mov_b32 v55, 0
  v_mov_b32 v56, 0
  v_mov_b32 v57, 0
  v_mov_b32 v58, 0
  v_mov_b32 v59, 0
  v_mov_b32 v60, 0
  v_mov_b32 v61, 0
  v_mov_b32 v62, 0
  v_mov_b32 v63, 0
  s_waitcnt lgkmcnt(0)
  s_mov_b32 s14, 0
  s_lshr_b32 s8, s14, 6
  s_add_u32 s8, s8, s36
  s_load_dwordx8 s[16:23], s[44:45], s8 glc
  s_add_u32 s9, s8, 512
  s_load_dwordx8 s[24:31], s[44:45], s9 glc
  s_barrier
  ds_read_b128 v[16:19], v192
  ds_read_b128 v[20:23], v192 offset:1024
  ds_read_b128 v[24:27], v193
  ds_read_b128 v[28:31], v193 offset:1024
  ds_read_b128 v[32:35], v194
  ds_read_b128 v[36:39], v194 offset:1024
  ds_read_b128 v[40:43], v195
  ds_read_b128 v[44:47], v195 offset:1024
  s_waitcnt lgkmcnt(0)
  s_xor_b64 s[16:17], s[16:17], s[40:41]
  s_xor_b64 s[18:19], s[18:19], s[40:41]
  s_or_b64 s[16:17], s[16:17], s[18:19]
  s_xor_b64 s[20:21], s[20:21], s[40:41]
  s_or_b64 s[16:17], s[16:17], s[20:21]
  s_xor_b64 s[22:23], s[22:23], s[40:41]
  s_or_b64 s[16:17], s[16:17], s[22:23]
  s_xor_b64 s[24:25], s[24:25], s[40:41]
  s_or_b64 s[16:17], s[16:17], s[24:25]
  s_xor_b64 s[26:27], s[26:27], s[40:41]
  s_or_b64 s[16:17], s[16:17], s[26:27]
  s_xor_b64 s[28:29], s[28:29], s[40:41]
  s_or_b64 s[16:17], s[16:17], s[28:29]
  s_xor_b64 s[30:31], s[30:31], s[40:41]
  s_or_b64 s[16:17], s[16:17], s[30:31]
  s_cbranch_scc1 L_nokv_55
  s_mov_b32 s75, 1
  s_mov_b32 s68, s32
  buffer_load_dwordx4 v[112:115], v15, s[56:59], s68 offen offset:0 sc1
  buffer_load_dwordx4 v[116:119], v15, s[56:59], s68 offen offset:1024 sc1
  buffer_load_dwordx4 v[120:123], v15, s[56:59], s68 offen offset:2048 sc1
  buffer_load_dwordx4 v[124:127], v15, s[56:59], s68 offen offset:3072 sc1
  s_mov_b32 s68, s33
  buffer_load_dwordx4 v[128:131], v15, s[56:59], s68 offen offset:0 sc1
  buffer_load_dwordx4 v[132:135], v15, s[56:59], s68 offen offset:1024 sc1
  buffer_load_dwordx4 v[136:139], v15, s[56:59], s68 offen offset:2048 sc1
  buffer_load_dwordx4 v[140:143], v15, s[56:59], s68 offen offset:3072 sc1
  s_mov_b32 s68, s34
  buffer_load_dwordx4 v[200:203], v15, s[56:59], s68 offen offset:0 sc1
  buffer_load_dwordx4 v[204:207], v15, s[56:59], s68 offen offset:1024 sc1
  buffer_load_dwordx4 v[208:211], v15, s[56:59], s68 offen offset:2048 sc1
  buffer_load_dwordx4 v[212:215], v15, s[56:59], s68 offen offset:3072 sc1
  s_mov_b32 s68, s35
  buffer_load_dwordx4 v[216:219], v15, s[56:59], s68 offen offset:0 sc1
  buffer_load_dwordx4 v[220:223], v15, s[56:59], s68 offen offset:1024 sc1
L_nokv_55:
  s_setprio 1
  v_mov_b32 v224, 0
  v_mov_b32 v225, 0
  v_mov_b32 v226, 0
  v_mov_b32 v227, 0
  v_mov_b32 v228, 0
  v_mov_b32 v229, 0
  v_mov_b32 v230, 0
  v_mov_b32 v231, 0
  s_cmp_lg_u32 s75, 0
  s_cbranch_scc1 L_go_56
L_again_57:
  s_mov_b32 s14, 0
  s_lshr_b32 s8, s14, 6
  s_add_u32 s8, s8, s36
  s_load_dwordx8 s[16:23], s[44:45], s8 glc
  s_add_u32 s9, s8, 512
  s_load_dwordx8 s[24:31], s[44:45], s9 glc
  s_waitcnt lgkmcnt(0)
  s_xor_b64 s[16:17], s[16:17], s[40:41]
  s_xor_b64 s[18:19], s[18:19], s[40:41]
  s_or_b64 s[16:17], s[16:17], s[18:19]
  s_xor_b64 s[20:21], s[20:21], s[40:41]
  s_or_b64 s[16:17], s[16:17], s[20:21]
  s_xor_b64 s[22:23], s[22:23], s[40:41]
  s_or_b64 s[16:17], s[16:17], s[22:23]
  s_xor_b64 s[24:25], s[24:25], s[40:41]
  s_or_b64 s[16:17], s[16:17], s[24:25]
  s_xor_b64 s[26:27], s[26:27], s[40:41]
  s_or_b64 s[16:17], s[16:17], s[26:27]
  s_xor_b64 s[28:29], s[28:29], s[40:41]
  s_or_b64 s[16:17], s[16:17], s[28:29]
  s_xor_b64 s[30:31], s[30:31], s[40:41]
  s_or_b64 s[16:17], s[16:17], s[30:31]
  s_cbranch_scc1 L_kvspin_58
L_kvback_59:
  s_mov_b32 s68, s32
  buffer_load_dwordx4 v[112:115], v15, s[56:59], s68 offen offset:0 sc1
  buffer_load_dwordx4 v[116:119], v15, s[56:59], s68 offen offset:1024 sc1
  buffer_load_dwordx4 v[120:123], v15, s[56:59], s68 offen offset:2048 sc1
  buffer_load_dwordx4 v[124:127], v15, s[56:59], s68 offen offset:3072 sc1
  s_mov_b32 s68, s33
  buffer_load_dwordx4 v[128:131], v15, s[56:59], s68 offen offset:0 sc1
  buffer_load_dwordx4 v[132:135], v15, s[56:59], s68 offen offset:1024 sc1
  buffer_load_dwordx4 v[136:139], v15, s[56:59], s68 offen offset:2048 sc1
  buffer_load_dwordx4 v[140:143], v15, s[56:59], s68 offen offset:3072 sc1
  s_mov_b32 s68, s34
  buffer_load_dwordx4 v[200:203], v15, s[56:59], s68 offen offset:0 sc1
  buffer_load_dwordx4 v[204:207], v15, s[56:59], s68 offen offset:1024 sc1
  buffer_load_dwordx4 v[208:211], v15, s[56:59], s68 offen offset:2048 sc1
  buffer_load_dwordx4 v[212:215], v15, s[56:59], s68 offen offset:3072 sc1
  s_mov_b32 s68, s35
  buffer_load_dwordx4 v[216:219], v15, s[56:59], s68 offen offset:0 sc1
  buffer_load_dwordx4 v[220:223], v15, s[56:59], s68 offen offset:1024 sc1
L_go_56:
  s_mov_b32 s74, 0x462
  s_waitcnt lgkmcnt(0)
  s_and_b32 s39, s74, 15
  s_lshl_b32 s39, s39, 15
  s_lshr_b32 s74, s74, 4
  s_lshr_b32 s8, s39, 6
  s_add_u32 s8, s8, s36
  s_load_dwordx8 s[16:23], s[44:45], s8 glc
  s_add_u32 s9, s8, 512
  s_load_dwordx8 s[24:31], s[44:45], s9 glc
  s_waitcnt vmcnt(12)
  v_mfma_f32_32x32x16_bf16 v[144:159], v[112:115], v[16:19], 0
  v_mfma_f32_32x32x16_bf16 v[144:159], v[116:119], v[20:23], v[144:159]
  s_mov_b32 s70, 3
  s_nop 10
.p2align 4
L_attn_60:
  v_mfma_f32_32x32x16_bf16 v[160:175], v[112:115], v[24:27], 0
  s_mov_b32 s14, s39
  v_exp_f32 v144, v144
  v_exp_f32 v145, v145
  v_exp_f32 v146, v146
  v_exp_f32 v147, v147
  v_perm_b32 v176, v145, v144, s38
  v_exp_f32 v148, v148
  v_mfma_f32_32x32x16_bf16 v[160:175], v[116:119], v[28:31], v[160:175]
  s_waitcnt lgkmcnt(0)
  s_xor_b64 s[16:17], s[16:17], s[40:41]
  v_exp_f32 v149, v149
  v_perm_b32 v177, v147, v146, s38
  v_exp_f32 v150, v150
  v_exp_f32 v151, v151
  v_perm_b32 v178, v149, v148, s38
  v_exp_f32 v152, v152
  v_mfma_f32_32x32x16_bf16 v[96:111], v[224:227], v[184:187], v[96:111]
  s_xor_b64 s[18:19], s[18:19], s[40:41]
  s_or_b64 s[16:17], s[16:17], s[18:19]
  v_exp_f32 v153, v153
  v_perm_b32 v179, v151, v150, s38
  v_exp_f32 v154, v154
  v_exp_f32 v155, v155
  v_perm_b32 v180, v153, v152, s38
  v_exp_f32 v156, v156
  v_mfma_f32_32x32x16_bf16 v[96:111], v[228:231], v[188:191], v[96:111]
  s_xor_b64 s[20:21], s[20:21], s[40:41]
  s_or_b64 s[16:17], s[16:17], s[20:21]
  v_exp_f32 v157, v157
  v_perm_b32 v181, v155, v154, s38
  v_exp_f32 v158, v158
  v_exp_f32 v159, v159
  v_perm_b32 v182, v157, v156, s38
  v_perm_b32 v183, v159, v158, s38
  v_mfma_f32_32x32x16_bf16 v[144:159], v[112:115], v[32:35], 0
  s_xor_b64 s[22:23], s[22:23], s[40:41]
  s_or_b64 s[16:17], s[16:17], s[22:23]
  v_exp_f32 v160, v160
  v_exp_f32 v161, v161
  v_exp_f32 v162, v162
  v_exp_f32 v163, v163
  v_perm_b32 v184, v161, v160, s38
  v_exp_f32 v164, v164
  v_mfma_f32_32x32x16_bf16 v[144:159], v[116:119], v[36:39], v[144:159]
  s_xor_b64 s[24:25], s[24:25], s[40:41]
  s_or_b64 s[16:17], s[16:17], s[24:25]
  v_exp_f32 v165, v165
  v_perm_b32 v185, v163, v162, s38
  v_exp_f32 v166, v166
  v_exp_f32 v167, v167
  v_perm_b32 v186, v165, v164, s38
  v_exp_f32 v168, v168
  s_waitcnt vmcnt(10)
  v_mfma_f32_32x32x16_bf16 v[48:63], v[120:123], v[176:179], v[48:63]
  buffer_load_dwordx4 v[224:227], v15, s[56:59], s68 offen offset:2048 sc1
  v_exp_f32 v169, v169
  v_perm_b32 v187, v167, v166, s38
  v_exp_f32 v170, v170
  v_exp_f32 v171, v171
  v_perm_b32 v188, v169, v168, s38
  v_exp_f32 v172, v172
  v_mfma_f32_32x32x16_bf16 v[48:63], v[124:127], v[180:183], v[48:63]
  buffer_load_dwordx4 v[228:231], v15, s[56:59], s68 offen offset:3072 sc1
  v_exp_f32 v173, v173
  v_perm_b32 v189, v171, v170, s38
  v_exp_f32 v174, v174
  v_exp_f32 v175, v175
  v_perm_b32 v190, v173, v172, s38
  v_perm_b32 v191, v175, v174, s38
  v_mfma_f32_32x32x16_bf16 v[160:175], v[112:115], v[40:43], 0
  s_xor_b64 s[26:27], s[26:27], s[40:41]
  s_or_b64 s[16:17], s[16:17], s[26:27]
  v_exp_f32 v144, v144
  v_exp_f32 v145, v145
  v_exp_f32 v146, v146
  v_exp_f32 v147, v147
  v_perm_b32 v176, v145, v144, s38
  v_exp_f32 v148, v148
  v_mfma_f32_32x32x16_bf16 v[160:175], v[116:119], v[44:47], v[160:175]
  s_xor_b64 s[28:29], s[28:29], s[40:41]
  s_or_b64 s[16:17], s[16:17], s[28:29]
  v_exp_f32 v149, v149
  v_perm_b32 v177, v147, v146, s38
  v_exp_f32 v150, v150
  v_exp_f32 v151, v151
  v_perm_b32 v178, v149, v148, s38
  v_exp_f32 v152, v152
  v_mfma_f32_32x32x16_bf16 v[64:79], v[120:123], v[184:187], v[64:79]
  s_xor_b64 s[30:31], s[30:31], s[40:41]
  s_or_b64 s[16:17], s[16:17], s[30:31]
  v_exp_f32 v153, v153
  v_perm_b32 v179, v151, v150, s38
  v_exp_f32 v154, v154
  v_exp_f32 v155, v155
  v_perm_b32 v180, v153, v152, s38
  v_exp_f32 v156, v156
  v_mfma_f32_32x32x16_bf16 v[64:79], v[124:127], v[188:191], v[64:79]
  s_cbranch_scc1 L_kvspin_61
L_kvback_62:
  v_exp_f32 v157, v157
  v_perm_b32 v181, v155, v154, s38
  v_exp_f32 v158, v158
  v_exp_f32 v159, v159
  v_perm_b32 v182, v157, v156, s38
  v_perm_b32 v183, v159, v158, s38
  s_waitcnt vmcnt(10)
  v_mfma_f32_32x32x16_bf16 v[144:159], v[128:131], v[16:19], 0
  s_add_u32 s68, s14, s32
  v_exp_f32 v160, v160
  v_exp_f32 v161, v161
  v_exp_f32 v162, v162
  v_exp_f32 v163, v163
  v_perm_b32 v184, v161, v160, s38
  v_exp_f32 v164, v164
  v_mfma_f32_32x32x16_bf16 v[144:159], v[132:135], v[20:23], v[144:159]
  v_exp_f32 v165, v165
  v_perm_b32 v185, v163, v162, s38
  v_exp_f32 v166, v166
  v_exp_f32 v167, v167
  v_perm_b32 v186, v165, v164, s38
  v_exp_f32 v168, v168
  v_mfma_f32_32x32x16_bf16 v[80:95], v[120:123], v[176:179], v[80:95]
  buffer_load_dwordx4 v[112:115], v15, s[56:59], s68 offen offset:0 sc1
  v_exp_f32 v169, v169
  v_perm_b32 v187, v167, v166, s38
  v_exp_f32 v170, v170
  v_exp_f32 v171, v171
  v_perm_b32 v188, v169, v168, s38
  v_exp_f32 v172, v172
  v_mfma_f32_32x32x16_bf16 v[80:95], v[124:127], v[180:183], v[80:95]
  buffer_load_dwordx4 v[116:119], v15, s[56:59], s68 offen offset:1024 sc1
  v_exp_f32 v173, v173
  v_perm_b32 v189, v171, v170, s38
  v_exp_f32 v174, v174
  v_exp_f32 v175, v175
  v_perm_b32 v190, v173, v172, s38
  v_perm_b32 v191, v175, v174, s38
  v_mfma_f32_32x32x16_bf16 v[160:175], v[128:131], v[24:27], 0
  v_exp_f32 v144, v144
  v_exp_f32 v145, v145
  v_exp_f32 v146, v146
  v_exp_f32 v147, v147
  v_perm_b32 v176, v145, v144, s38
  v_exp_f32 v148, v148
  v_mfma_f32_32x32x16_bf16 v[160:175], v[132:135], v[28:31], v[160:175]
  v_exp_f32 v149, v149
  v_perm_b32 v177, v147, v146, s38
  v_exp_f32 v150, v150
  v_exp_f32 v151, v151
  v_perm_b32 v178, v149, v148, s38
  v_exp_f32 v152, v152
  v_mfma_f32_32x32x16_bf16 v[96:111], v[120:123], v[184:187], v[96:111]
  v_exp_f32 v153, v153
  v_perm_b32 v179, v151, v150, s38
  v_exp_f32 v154, v154
  v_exp_f32 v155, v155
  v_perm_b32 v180, v153, v152, s38
  v_exp_f32 v156, v156
  v_mfma_f32_32x32x16_bf16 v[96:111], v[124:127], v[188:191], v[96:111]
  v_exp_f32 v157, v157
  v_perm_b32 v181, v155, v154, s38
  v_exp_f32 v158, v158
  v_exp_f32 v159, v159
  v_perm_b32 v182, v157, v156, s38
  v_perm_b32 v183, v159, v158, s38
  v_mfma_f32_32x32x16_bf16 v[144:159], v[128:131], v[32:35], 0
  v_exp_f32 v160, v160
  v_exp_f32 v161, v161
  v_exp_f32 v162, v162
  v_exp_f32 v163, v163
  v_perm_b32 v184, v161, v160, s38
  v_exp_f32 v164, v164
  v_mfma_f32_32x32x16_bf16 v[144:159], v[132:135], v[36:39], v[144:159]
  v_exp_f32 v165, v165
  v_perm_b32 v185, v163, v162, s38
  v_exp_f32 v166, v166
  v_exp_f32 v167, v167
  v_perm_b32 v186, v165, v164, s38
  v_exp_f32 v168, v168
  s_waitcnt vmcnt(10)
  v_mfma_f32_32x32x16_bf16 v[48:63], v[136:139], v[176:179], v[48:63]
  buffer_load_dwordx4 v[120:123], v15, s[56:59], s68 offen offset:2048 sc1
  v_exp_f32 v169, v169
  v_perm_b32 v187, v167, v166, s38
  v_exp_f32 v170, v170
  v_exp_f32 v171, v171
  v_perm_b32 v188, v169, v168, s38
  v_exp_f32 v172, v172
  v_mfma_f32_32x32x16_bf16 v[48:63], v[140:143], v[180:183], v[48:63]
  buffer_load_dwordx4 v[124:127], v15, s[56:59], s68 offen offset:3072 sc1
  v_exp_f32 v173, v173
  v_perm_b32 v189, v171, v170, s38
  v_exp_f32 v174, v174
  v_exp_f32 v175, v175
  v_perm_b32 v190, v173, v172, s38
  v_perm_b32 v191, v175, v174, s38
  v_mfma_f32_32x32x16_bf16 v[160:175], v[128:131], v[40:43], 0
  v_exp_f32 v144, v144
  v_exp_f32 v145, v145
  v_exp_f32 v146, v146
  v_exp_f32 v147, v147
  v_perm_b32 v176, v145, v144, s38
  v_exp_f32 v148, v148
  v_mfma_f32_32x32x16_bf16 v[160:175], v[132:135], v[44:47], v[160:175]
  v_exp_f32 v149, v149
  v_perm_b32 v177, v147, v146, s38
  v_exp_f32 v150, v150
  v_exp_f32 v151, v151
  v_perm_b32 v178, v149, v148, s38
  v_exp_f32 v152, v152
  v_mfma_f32_32x32x16_bf16 v[64:79], v[136:139], v[184:187], v[64:79]
  v_exp_f32 v153, v153
  v_perm_b32 v179, v151, v150, s38
  v_exp_f32 v154, v154
  v_exp_f32 v155, v155
  v_perm_b32 v180, v153, v152, s38
  v_exp_f32 v156, v156
  v_mfma_f32_32x32x16_bf16 v[64:79], v[140:143], v[188:191], v[64:79]
  v_exp_f32 v157, v157
  v_perm_b32 v181, v155, v154, s38
  v_exp_f32 v158, v158
  v_exp_f32 v159, v159
  v_perm_b32 v182, v157, v156, s38
  v_perm_b32 v183, v159, v158, s38
  s_waitcnt vmcnt(10)
  v_mfma_f32_32x32x16_bf16 v[144:159], v[200:203], v[16:19], 0
  s_add_u32 s68, s14, s33
  v_exp_f32 v160, v160
  v_exp_f32 v161, v161
  v_exp_f32 v162, v162
  v_exp_f32 v163, v163
  v_perm_b32 v184, v161, v160, s38
  v_exp_f32 v164, v164
  v_mfma_f32_32x32x16_bf16 v[144:159], v[204:207], v[20:23], v[144:159]
  v_exp_f32 v165, v165
  v_perm_b32 v185, v163, v162, s38
  v_exp_f32 v166, v166
  v_exp_f32 v167, v167
  v_perm_b32 v186, v165, v164, s38
  v_exp_f32 v168, v168
  v_mfma_f32_32x32x16_bf16 v[80:95], v[136:139], v[176:179], v[80:95]
  buffer_load_dwordx4 v[128:131], v15, s[56:59], s68 offen offset:0 sc1
  v_exp_f32 v169, v169
  v_perm_b32 v187, v167, v166, s38
  v_exp_f32 v170, v170
  v_exp_f32 v171, v171
  v_perm_b32 v188, v169, v168, s38
  v_exp_f32 v172, v172
  v_mfma_f32_32x32x16_bf16 v[80:95], v[140:143], v[180:183], v[80:95]
  buffer_load_dwordx4 v[132:135], v15, s[56:59], s68 offen offset:1024 sc1
  v_exp_f32 v173, v173
  v_perm_b32 v189, v171, v170, s38
  v_exp_f32 v174, v174
  v_exp_f32 v175, v175
  v_perm_b32 v190, v173, v172, s38
  v_perm_b32 v191, v175, v174, s38
  v_mfma_f32_32x32x16_bf16 v[160:175], v[200:203], v[24:27], 0
  v_exp_f32 v144, v144
  v_exp_f32 v145, v145
  v_exp_f32 v146, v146
  v_exp_f32 v147, v147
  v_perm_b32 v176, v145, v144, s38
  v_exp_f32 v148, v148
  v_mfma_f32_32x32x16_bf16 v[160:175], v[204:207], v[28:31], v[160:175]
  v_exp_f32 v149, v149
  v_perm_b32 v177, v147, v146, s38
  v_exp_f32 v150, v150
  v_exp_f32 v151, v151
  v_perm_b32 v178, v149, v148, s38
  v_exp_f32 v152, v152
  v_mfma_f32_32x32x16_bf16 v[96:111], v[136:139], v[184:187], v[96:111]
  v_exp_f32 v153, v153
  v_perm_b32 v179, v151, v150, s38
  v_exp_f32 v154, v154
  v_exp_f32 v155, v155
  v_perm_b32 v180, v153, v152, s38
  v_exp_f32 v156, v156
  v_mfma_f32_32x32x16_bf16 v[96:111], v[140:143], v[188:191], v[96:111]
  v_exp_f32 v157, v157
  v_perm_b32 v181, v155, v154, s38
  v_exp_f32 v158, v158
  v_exp_f32 v159, v159
  v_perm_b32 v182, v157, v156, s38
  v_perm_b32 v183, v159, v158, s38
  v_mfma_f32_32x32x16_bf16 v[144:159], v[200:203], v[32:35], 0
  v_exp_f32 v160, v160
  v_exp_f32 v161, v161
  v_exp_f32 v162, v162
  v_exp_f32 v163, v163
  v_perm_b32 v184, v161, v160, s38
  v_exp_f32 v164, v164
  v_mfma_f32_32x32x16_bf16 v[144:159], v[204:207], v[36:39], v[144:159]
  v_exp_f32 v165, v165
  v_perm_b32 v185, v163, v162, s38
  v_exp_f32 v166, v166
  v_exp_f32 v167, v167
  v_perm_b32 v186, v165, v164, s38
  v_exp_f32 v168, v168
  s_waitcnt vmcnt(10)
  v_mfma_f32_32x32x16_bf16 v[48:63], v[208:211], v[176:179], v[48:63]
  buffer_load_dwordx4 v[136:139], v15, s[56:59], s68 offen offset:2048 sc1
  v_exp_f32 v169, v169
  v_perm_b32 v187, v167, v166, s38
  v_exp_f32 v170, v170
  v_exp_f32 v171, v171
  v_perm_b32 v188, v169, v168, s38
  v_exp_f32 v172, v172
  v_mfma_f32_32x32x16_bf16 v[48:63], v[212:215], v[180:183], v[48:63]
  buffer_load_dwordx4 v[140:143], v15, s[56:59], s68 offen offset:3072 sc1
  v_exp_f32 v173, v173
  v_perm_b32 v189, v171, v170, s38
  v_exp_f32 v174, v174
  v_exp_f32 v175, v175
  v_perm_b32 v190, v173, v172, s38
  v_perm_b32 v191, v175, v174, s38
  v_mfma_f32_32x32x16_bf16 v[160:175], v[200:203], v[40:43], 0
  v_exp_f32 v144, v144
  v_exp_f32 v145, v145
  v_exp_f32 v146, v146
  v_exp_f32 v147, v147
  v_perm_b32 v176, v145, v144, s38
  v_exp_f32 v148, v148
  v_mfma_f32_32x32x16_bf16 v[160:175], v[204:207], v[44:47], v[160:175]
  v_exp_f32 v149, v149
  v_perm_b32 v177, v147, v146, s38
  v_exp_f32 v150, v150
  v_exp_f32 v151, v151
  v_perm_b32 v178, v149, v148, s38
  v_exp_f32 v152, v152
  v_mfma_f32_32x32x16_bf16 v[64:79], v[208:211], v[184:187], v[64:79]
  v_exp_f32 v153, v153
  v_perm_b32 v179, v151, v150, s38
  v_exp_f32 v154, v154
  v_exp_f32 v155, v155
  v_perm_b32 v180, v153, v152, s38
  v_exp_f32 v156, v156
  v_mfma_f32_32x32x16_bf16 v[64:79], v[212:215], v[188:191], v[64:79]
  v_exp_f32 v157, v157
  v_perm_b32 v181, v155, v154, s38
  v_exp_f32 v158, v158
  v_exp_f32 v159, v159
  v_perm_b32 v182, v157, v156, s38
  v_perm_b32 v183, v159, v158, s38
  s_waitcnt vmcnt(10)
  v_mfma_f32_32x32x16_bf16 v[144:159], v[216:219], v[16:19], 0
  s_add_u32 s68, s14, s34
  v_exp_f32 v160, v160
  v_exp_f32 v161, v161
  v_exp_f32 v162, v162
  v_exp_f32 v163, v163
  v_perm_b32 v184, v161, v160, s38
  v_exp_f32 v164, v164
  v_mfma_f32_32x32x16_bf16 v[144:159], v[220:223], v[20:23], v[144:159]
  v_exp_f32 v165, v165
  v_perm_b32 v185, v163, v162, s38
  v_exp_f32 v166, v166
  v_exp_f32 v167, v167
  v_perm_b32 v186, v165, v164, s38
  v_exp_f32 v168, v168
  v_mfma_f32_32x32x16_bf16 v[80:95], v[208:211], v[176:179], v[80:95]
  buffer_load_dwordx4 v[200:203], v15, s[56:59], s68 offen offset:0 sc1
  v_exp_f32 v169, v169
  v_perm_b32 v187, v167, v166, s38
  v_exp_f32 v170, v170
  v_exp_f32 v171, v171
  v_perm_b32 v188, v169, v168, s38
  v_exp_f32 v172, v172
  v_mfma_f32_32x32x16_bf16 v[80:95], v[212:215], v[180:183], v[80:95]
  buffer_load_dwordx4 v[204:207], v15, s[56:59], s68 offen offset:1024 sc1
  v_exp_f32 v173, v173
  v_perm_b32 v189, v171, v170, s38
  v_exp_f32 v174, v174
  v_exp_f32 v175, v175
  v_perm_b32 v190, v173, v172, s38
  v_perm_b32 v191, v175, v174, s38
  v_mfma_f32_32x32x16_bf16 v[160:175], v[216:219], v[24:27], 0
  s_and_b32 s39, s74, 15
  v_exp_f32 v144, v144
  v_exp_f32 v145, v145
  v_exp_f32 v146, v146
  v_exp_f32 v147, v147
  v_perm_b32 v176, v145, v144, s38
  v_exp_f32 v148, v148
  v_mfma_f32_32x32x16_bf16 v[160:175], v[220:223], v[28:31], v[160:175]
  s_lshl_b32 s39, s39, 15
  v_exp_f32 v149, v149
  v_perm_b32 v177, v147, v146, s38
  v_exp_f32 v150, v150
  v_exp_f32 v151, v151
  v_perm_b32 v178, v149, v148, s38
  v_exp_f32 v152, v152
  v_mfma_f32_32x32x16_bf16 v[96:111], v[208:211], v[184:187], v[96:111]
  s_lshr_b32 s74, s74, 4
  v_exp_f32 v153, v153
  v_perm_b32 v179, v151, v150, s38
  v_exp_f32 v154, v154
  v_exp_f32 v155, v155
  v_perm_b32 v180, v153, v152, s38
  v_exp_f32 v156, v156
  v_mfma_f32_32x32x16_bf16 v[96:111], v[212:215], v[188:191], v[96:111]
  s_lshr_b32 s8, s39, 6
  v_exp_f32 v157, v157
  v_perm_b32 v181, v155, v154, s38
  v_exp_f32 v158, v158
  v_exp_f32 v159, v159
  v_perm_b32 v182, v157, v156, s38
  v_perm_b32 v183, v159, v158, s38
  v_mfma_f32_32x32x16_bf16 v[144:159], v[216:219], v[32:35], 0
  s_add_u32 s8, s8, s36
  v_exp_f32 v160, v160
  v_exp_f32 v161, v161
  v_exp_f32 v162, v162
  v_exp_f32 v163, v163
  v_perm_b32 v184, v161, v160, s38
  v_exp_f32 v164, v164
  v_mfma_f32_32x32x16_bf16 v[144:159], v[220:223], v[36:39], v[144:159]
  s_load_dwordx8 s[16:23], s[44:45], s8 glc
  s_cmp_lg_u32 s70, 1
  s_cbranch_scc1 L_tsk_63
  buffer_store_dword v199, v248, s[56:59], s69 offen offset:4 sc1
L_tsk_63:
  v_exp_f32 v165, v165
  v_perm_b32 v185, v163, v162, s38
  v_exp_f32 v166, v166
  v_exp_f32 v167, v167
  v_perm_b32 v186, v165, v164, s38
  v_exp_f32 v168, v168
  s_waitcnt vmcnt(10)
  v_mfma_f32_32x32x16_bf16 v[48:63], v[224:227], v[176:179], v[48:63]
  buffer_load_dwordx4 v[208:211], v15, s[56:59], s68 offen offset:2048 sc1
  v_exp_f32 v169, v169
  v_perm_b32 v187, v167, v166, s38
  v_exp_f32 v170, v170
  v_exp_f32 v171, v171
  v_perm_b32 v188, v169, v168, s38
  v_exp_f32 v172, v172
  v_mfma_f32_32x32x16_bf16 v[48:63], v[228:231], v[180:183], v[48:63]
  buffer_load_dwordx4 v[212:215], v15, s[56:59], s68 offen offset:3072 sc1
  v_exp_f32 v173, v173
  v_perm_b32 v189, v171, v170, s38
  v_exp_f32 v174, v174
  v_exp_f32 v175, v175
  v_perm_b32 v190, v173, v172, s38
  v_perm_b32 v191, v175, v174, s38
  v_mfma_f32_32x32x16_bf16 v[160:175], v[216:219], v[40:43], 0
  s_sub_u32 s70, s70, 1
  v_exp_f32 v144, v144
  v_exp_f32 v145, v145
  v_exp_f32 v146, v146
  v_exp_f32 v147, v147
  v_perm_b32 v176, v145, v144, s38
  v_exp_f32 v148, v148
  v_mfma_f32_32x32x16_bf16 v[160:175], v[220:223], v[44:47], v[160:175]
  s_add_u32 s9, s8, 512
  v_exp_f32 v149, v149
  v_perm_b32 v177, v147, v146, s38
  v_exp_f32 v150, v150
  v_exp_f32 v151, v151
  v_perm_b32 v178, v149, v148, s38
  v_exp_f32 v152, v152
  v_mfma_f32_32x32x16_bf16 v[64:79], v[224:227], v[184:187], v[64:79]
  s_load_dwordx8 s[24:31], s[44:45], s9 glc
  v_exp_f32 v153, v153
  v_perm_b32 v179, v151, v150, s38
  v_exp_f32 v154, v154
  v_exp_f32 v155, v155
  v_perm_b32 v180, v153, v152, s38
  v_exp_f32 v156, v156
  v_mfma_f32_32x32x16_bf16 v[64:79], v[228:231], v[188:191], v[64:79]
  v_exp_f32 v157, v157
  v_perm_b32 v181, v155, v154, s38
  v_exp_f32 v158, v158
  v_exp_f32 v159, v159
  v_perm_b32 v182, v157, v156, s38
  v_perm_b32 v183, v159, v158, s38
  s_waitcnt vmcnt(10)
  v_mfma_f32_32x32x16_bf16 v[144:159], v[112:115], v[16:19], 0
  s_add_u32 s68, s14, s35
  v_exp_f32 v160, v160
  v_exp_f32 v161, v161
  v_exp_f32 v162, v162
  v_exp_f32 v163, v163
  v_perm_b32 v184, v161, v160, s38
  v_exp_f32 v164, v164
  v_mfma_f32_32x32x16_bf16 v[144:159], v[116:119], v[20:23], v[144:159]
  v_exp_f32 v165, v165
  v_perm_b32 v185, v163, v162, s38
  v_exp_f32 v166, v166
  v_exp_f32 v167, v167
  v_perm_b32 v186, v165, v164, s38
  v_exp_f32 v168, v168
  v_mfma_f32_32x32x16_bf16 v[80:95], v[224:227], v[176:179], v[80:95]
  buffer_load_dwordx4 v[216:219], v15, s[56:59], s68 offen offset:0 sc1
  v_exp_f32 v169, v169
  v_perm_b32 v187, v167, v166, s38
  v_exp_f32 v170, v170
  v_exp_f32 v171, v171
  v_perm_b32 v188, v169, v168, s38
  v_exp_f32 v172, v172
  v_mfma_f32_32x32x16_bf16 v[80:95], v[228:231], v[180:183], v[80:95]
  buffer_load_dwordx4 v[220:223], v15, s[56:59], s68 offen offset:1024 sc1
  v_exp_f32 v173, v173
  v_perm_b32 v189, v171, v170, s38
  v_exp_f32 v174, v174
  v_exp_f32 v175, v175
  v_perm_b32 v190, v173, v172, s38
  v_perm_b32 v191, v175, v174, s38
  s_cmp_lg_u32 s70, 0
  s_cbranch_scc1 L_attn_60
  v_mfma_f32_32x32x16_bf16 v[160:175], v[112:115], v[24:27], 0
  v_exp_f32 v144, v144
  v_exp_f32 v145, v145
  v_exp_f32 v146, v146
  v_exp_f32 v147, v147
  v_perm_b32 v176, v145, v144, s38
  v_exp_f32 v148, v148
  v_mfma_f32_32x32x16_bf16 v[160:175], v[116:119], v[28:31], v[160:175]
  v_exp_f32 v149, v149
  v_perm_b32 v177, v147, v146, s38
  v_exp_f32 v150, v150
  v_exp_f32 v151, v151
  v_perm_b32 v178, v149, v148, s38
  v_exp_f32 v152, v152
  v_mfma_f32_32x32x16_bf16 v[96:111], v[224:227], v[184:187], v[96:111]
  v_exp_f32 v153, v153
  v_perm_b32 v179, v151, v150, s38
  v_exp_f32 v154, v154
  v_exp_f32 v155, v155
  v_perm_b32 v180, v153, v152, s38
  v_exp_f32 v156, v156
  v_mfma_f32_32x32x16_bf16 v[96:111], v[228:231], v[188:191], v[96:111]
  v_exp_f32 v157, v157
  v_perm_b32 v181, v155, v154, s38
  v_exp_f32 v158, v158
  v_exp_f32 v159, v159
  v_perm_b32 v182, v157, v156, s38
  v_perm_b32 v183, v159, v158, s38
  v_mfma_f32_32x32x16_bf16 v[144:159], v[112:115], v[32:35], 0
  v_exp_f32 v160, v160
  v_exp_f32 v161, v161
  v_exp_f32 v162, v162
  v_exp_f32 v163, v163
  v_perm_b32 v184, v161, v160, s38
  v_exp_f32 v164, v164
  v_mfma_f32_32x32x16_bf16 v[144:159], v[116:119], v[36:39], v[144:159]
  v_exp_f32 v165, v165
  v_perm_b32 v185, v163, v162, s38
  v_exp_f32 v166, v166
  v_exp_f32 v167, v167
  v_perm_b32 v186, v165, v164, s38
  v_exp_f32 v168, v168
  s_waitcnt vmcnt(10)
  v_mfma_f32_32x32x16_bf16 v[48:63], v[120:123], v[176:179], v[48:63]
  buffer_load_dwordx4 v[224:227], v15, s[56:59], s68 offen offset:2048 sc1
  v_exp_f32 v169, v169
  v_perm_b32 v187, v167, v166, s38
  v_exp_f32 v170, v170
  v_exp_f32 v171, v171
  v_perm_b32 v188, v169, v168, s38
  v_exp_f32 v172, v172
  v_mfma_f32_32x32x16_bf16 v[48:63], v[124:127], v[180:183], v[48:63]
  buffer_load_dwordx4 v[228:231], v15, s[56:59], s68 offen offset:3072 sc1
  v_exp_f32 v173, v173
  v_perm_b32 v189, v171, v170, s38
  v_exp_f32 v174, v174
  v_exp_f32 v175, v175
  v_perm_b32 v190, v173, v172, s38
  v_perm_b32 v191, v175, v174, s38
  v_mfma_f32_32x32x16_bf16 v[160:175], v[112:115], v[40:43], 0
  s_add_u32 m0, s71, 49152
  v_exp_f32 v144, v144
  v_exp_f32 v145, v145
  v_exp_f32 v146, v146
  v_exp_f32 v147, v147
  v_perm_b32 v176, v145, v144, s38
  v_exp_f32 v148, v148
  s_mov_b32 s13, 179200
  v_mfma_f32_32x32x16_bf16 v[160:175], v[116:119], v[44:47], v[160:175]
  buffer_load_dwordx4 v249, s[64:67], s13 offen lds
  v_exp_f32 v149, v149
  v_perm_b32 v177, v147, v146, s38
  v_exp_f32 v150, v150
  v_exp_f32 v151, v151
  v_perm_b32 v178, v149, v148, s38
  v_exp_f32 v152, v152
  v_mfma_f32_32x32x16_bf16 v[64:79], v[120:123], v[184:187], v[64:79]
  v_exp_f32 v153, v153
  v_perm_b32 v179, v151, v150, s38
  v_exp_f32 v154, v154
  v_exp_f32 v155, v155
  v_perm_b32 v180, v153, v152, s38
  v_exp_f32 v156, v156
  v_mfma_f32_32x32x16_bf16 v[64:79], v[124:127], v[188:191], v[64:79]
  v_exp_f32 v157, v157
  v_perm_b32 v181, v155, v154, s38
  v_exp_f32 v158, v158
  v_exp_f32 v159, v159
  v_perm_b32 v182, v157, v156, s38
  v_perm_b32 v183, v159, v158, s38
  s_waitcnt vmcnt(11)
  v_mfma_f32_32x32x16_bf16 v[144:159], v[128:131], v[16:19], 0
  s_add_u32 m0, s71, 53248
  v_exp_f32 v160, v160
  v_exp_f32 v161, v161
  v_exp_f32 v162, v162
  v_exp_f32 v163, v163
  v_perm_b32 v184, v161, v160, s38
  v_exp_f32 v164, v164
  s_mov_b32 s13, 207872
  v_mfma_f32_32x32x16_bf16 v[144:159], v[132:135], v[20:23], v[144:159]
  buffer_load_dwordx4 v249, s[64:67], s13 offen lds
  v_exp_f32 v165, v165
  v_perm_b32 v185, v163, v162, s38
  v_exp_f32 v166, v166
  v_exp_f32 v167, v167
  v_perm_b32 v186, v165, v164, s38
  v_exp_f32 v168, v168
  v_mfma_f32_32x32x16_bf16 v[80:95], v[120:123], v[176:179], v[80:95]
  v_exp_f32 v169, v169
  v_perm_b32 v187, v167, v166, s38
  v_exp_f32 v170, v170
  v_exp_f32 v171, v171
  v_perm_b32 v188, v169, v168, s38
  v_exp_f32 v172, v172
  v_mfma_f32_32x32x16_bf16 v[80:95], v[124:127], v[180:183], v[80:95]
  v_exp_f32 v173, v173
  v_perm_b32 v189, v171, v170, s38
  v_exp_f32 v174, v174
  v_exp_f32 v175, v175
  v_perm_b32 v190, v173, v172, s38
  v_perm_b32 v191, v175, v174, s38
  v_mfma_f32_32x32x16_bf16 v[160:175], v[128:131], v[24:27], 0
  s_add_u32 m0, s71, 57344
  v_exp_f32 v144, v144
  v_exp_f32 v145, v145
  v_exp_f32 v146, v146
  v_exp_f32 v147, v147
  v_perm_b32 v176, v145, v144, s38
  v_exp_f32 v148, v148
  s_mov_b32 s13, 236544
  v_mfma_f32_32x32x16_bf16 v[160:175], v[132:135], v[28:31], v[160:175]
  buffer_load_dwordx4 v249, s[64:67], s13 offen lds
  v_exp_f32 v149, v149
  v_perm_b32 v177, v147, v146, s38
  v_exp_f32 v150, v150
  v_exp_f32 v151, v151
  v_perm_b32 v178, v149, v148, s38
  v_exp_f32 v152, v152
  v_mfma_f32_32x32x16_bf16 v[96:111], v[120:123], v[184:187], v[96:111]
  v_exp_f32 v153, v153
  v_perm_b32 v179, v151, v150, s38
  v_exp_f32 v154, v154
  v_exp_f32 v155, v155
  v_perm_b32 v180, v153, v152, s38
  v_exp_f32 v156, v156
  v_mfma_f32_32x32x16_bf16 v[96:111], v[124:127], v[188:191], v[96:111]
  v_exp_f32 v157, v157
  v_perm_b32 v181, v155, v154, s38
  v_exp_f32 v158, v158
  v_exp_f32 v159, v159
  v_perm_b32 v182, v157, v156, s38
  v_perm_b32 v183, v159, v158, s38
  v_mfma_f32_32x32x16_bf16 v[144:159], v[128:131], v[32:35], 0
  s_add_u32 m0, s71, 61440
  v_exp_f32 v160, v160
  v_exp_f32 v161, v161
  v_exp_f32 v162, v162
  v_exp_f32 v163, v163
  v_perm_b32 v184, v161, v160, s38
  v_exp_f32 v164, v164
  s_mov_b32 s13, 265216
  v_mfma_f32_32x32x16_bf16 v[144:159], v[132:135], v[36:39], v[144:159]
  buffer_load_dwordx4 v249, s[64:67], s13 offen lds
  v_exp_f32 v165, v165
  v_perm_b32 v185, v163, v162, s38
  v_exp_f32 v166, v166
  v_exp_f32 v167, v167
  v_perm_b32 v186, v165, v164, s38
  v_exp_f32 v168, v168
  s_waitcnt vmcnt(12)
  v_mfma_f32_32x32x16_bf16 v[48:63], v[136:139], v[176:179], v[48:63]
  v_exp_f32 v169, v169
  v_perm_b32 v187, v167, v166, s38
  v_exp_f32 v170, v170
  v_exp_f32 v171, v171
  v_perm_b32 v188, v169, v168, s38
  v_exp_f32 v172, v172
  v_mfma_f32_32x32x16_bf16 v[48:63], v[140:143], v[180:183], v[48:63]
  v_exp_f32 v173, v173
  v_perm_b32 v189, v171, v170, s38
  v_exp_f32 v174, v174
  v_exp_f32 v175, v175
  v_perm_b32 v190, v173, v172, s38
  v_perm_b32 v191, v175, v174, s38
  v_mfma_f32_32x32x16_bf16 v[160:175], v[128:131], v[40:43], 0
  s_add_u32 m0, s71, 65536
  v_exp_f32 v144, v144
  v_exp_f32 v145, v145
  v_exp_f32 v146, v146
  v_exp_f32 v147, v147
  v_perm_b32 v176, v145, v144, s38
  v_exp_f32 v148, v148
  s_mov_b32 s13, 293888
  v_mfma_f32_32x32x16_bf16 v[160:175], v[132:135], v[44:47], v[160:175]
  buffer_load_dwordx4 v249, s[64:67], s13 offen lds
  v_exp_f32 v149, v149
  v_perm_b32 v177, v147, v146, s38
  v_exp_f32 v150, v150
  v_exp_f32 v151, v151
  v_perm_b32 v178, v149, v148, s38
  v_exp_f32 v152, v152
  v_mfma_f32_32x32x16_bf16 v[64:79], v[136:139], v[184:187], v[64:79]
  v_exp_f32 v153, v153
  v_perm_b32 v179, v151, v150, s38
  v_exp_f32 v154, v154
  v_exp_f32 v155, v155
  v_perm_b32 v180, v153, v152, s38
  v_exp_f32 v156, v156
  v_mfma_f32_32x32x16_bf16 v[64:79], v[140:143], v[188:191], v[64:79]
  v_exp_f32 v157, v157
  v_perm_b32 v181, v155, v154, s38
  v_exp_f32 v158, v158
  v_exp_f32 v159, v159
  v_perm_b32 v182, v157, v156, s38
  v_perm_b32 v183, v159, v158, s38
  s_waitcnt vmcnt(11)
  v_mfma_f32_32x32x16_bf16 v[144:159], v[200:203], v[16:19], 0
  s_add_u32 m0, s71, 69632
  v_exp_f32 v160, v160
  v_exp_f32 v161, v161
  v_exp_f32 v162, v162
  v_exp_f32 v163, v163
  v_perm_b32 v184, v161, v160, s38
  v_exp_f32 v164, v164
  s_mov_b32 s13, 322560
  v_mfma_f32_32x32x16_bf16 v[144:159], v[204:207], v[20:23], v[144:159]
  buffer_load_dwordx4 v249, s[64:67], s13 offen lds
  v_exp_f32 v165, v165
  v_perm_b32 v185, v163, v162, s38
  v_exp_f32 v166, v166
  v_exp_f32 v167, v167
  v_perm_b32 v186, v165, v164, s38
  v_exp_f32 v168, v168
  v_mfma_f32_32x32x16_bf16 v[80:95], v[136:139], v[176:179], v[80:95]
  v_exp_f32 v169, v169
  v_perm_b32 v187, v167, v166, s38
  v_exp_f32 v170, v170
  v_exp_f32 v171, v171
  v_perm_b32 v188, v169, v168, s38
  v_exp_f32 v172, v172
  v_mfma_f32_32x32x16_bf16 v[80:95], v[140:143], v[180:183], v[80:95]
  v_exp_f32 v173, v173
  v_perm_b32 v189, v171, v170, s38
  v_exp_f32 v174, v174
  v_exp_f32 v175, v175
  v_perm_b32 v190, v173, v172, s38
  v_perm_b32 v191, v175, v174, s38
  v_mfma_f32_32x32x16_bf16 v[160:175], v[200:203], v[24:27], 0
  s_add_u32 m0, s71, 73728
  v_exp_f32 v144, v144
  v_exp_f32 v145, v145
  v_exp_f32 v146, v146
  v_exp_f32 v147, v147
  v_perm_b32 v176, v145, v144, s38
  v_exp_f32 v148, v148
  s_mov_b32 s13, 351232
  v_mfma_f32_32x32x16_bf16 v[160:175], v[204:207], v[28:31], v[160:175]
  buffer_load_dwordx4 v249, s[64:67], s13 offen lds
  v_exp_f32 v149, v149
  v_perm_b32 v177, v147, v146, s38
  v_exp_f32 v150, v150
  v_exp_f32 v151, v151
  v_perm_b32 v178, v149, v148, s38
  v_exp_f32 v152, v152
  v_mfma_f32_32x32x16_bf16 v[96:111], v[136:139], v[184:187], v[96:111]
  s_mov_b32 s11, 0
  v_exp_f32 v153, v153
  v_perm_b32 v179, v151, v150, s38
  v_exp_f32 v154, v154
  v_exp_f32 v155, v155
  v_perm_b32 v180, v153, v152, s38
  v_exp_f32 v156, v156
  v_mfma_f32_32x32x16_bf16 v[96:111], v[140:143], v[188:191], v[96:111]
  buffer_load_dwordx4 v[112:115], v249, s[64:67], s11 offen
  v_exp_f32 v157, v157
  v_perm_b32 v181, v155, v154, s38
  v_exp_f32 v158, v158
  v_exp_f32 v159, v159
  v_perm_b32 v182, v157, v156, s38
  v_perm_b32 v183, v159, v158, s38
  v_mfma_f32_32x32x16_bf16 v[144:159], v[200:203], v[32:35], 0
  s_add_u32 m0, s71, 77824
  v_exp_f32 v160, v160
  v_exp_f32 v161, v161
  v_exp_f32 v162, v162
  v_exp_f32 v163, v163
  v_perm_b32 v184, v161, v160, s38
  v_exp_f32 v164, v164
  s_mov_b32 s13, 379904
  v_mfma_f32_32x32x16_bf16 v[144:159], v[204:207], v[36:39], v[144:159]
  buffer_load_dwordx4 v249, s[64:67], s13 offen lds
  v_exp_f32 v165, v165
  v_perm_b32 v185, v163, v162, s38
  v_exp_f32 v166, v166
  v_exp_f32 v167, v167
  v_perm_b32 v186, v165, v164, s38
  v_exp_f32 v168, v168
  s_waitcnt vmcnt(13)
  v_mfma_f32_32x32x16_bf16 v[48:63], v[208:211], v[176:179], v[48:63]
  s_mov_b32 s11, 28672
  v_exp_f32 v169, v169
  v_perm_b32 v187, v167, v166, s38
  v_exp_f32 v170, v170
  v_exp_f32 v171, v171
  v_perm_b32 v188, v169, v168, s38
  v_exp_f32 v172, v172
  v_mfma_f32_32x32x16_bf16 v[48:63], v[212:215], v[180:183], v[48:63]
  buffer_load_dwordx4 v[116:119], v249, s[64:67], s11 offen
  v_exp_f32 v173, v173
  v_perm_b32 v189, v171, v170, s38
  v_exp_f32 v174, v174
  v_exp_f32 v175, v175
  v_perm_b32 v190, v173, v172, s38
  v_perm_b32 v191, v175, v174, s38
  v_mfma_f32_32x32x16_bf16 v[160:175], v[200:203], v[40:43], 0
  v_exp_f32 v144, v144
  v_exp_f32 v145, v145
  v_exp_f32 v146, v146
  v_exp_f32 v147, v147
  v_perm_b32 v176, v145, v144, s38
  v_exp_f32 v148, v148
  v_mfma_f32_32x32x16_bf16 v[160:175], v[204:207], v[44:47], v[160:175]
  v_exp_f32 v149, v149
  v_perm_b32 v177, v147, v146, s38
  v_exp_f32 v150, v150
  v_exp_f32 v151, v151
  v_perm_b32 v178, v149, v148, s38
  v_exp_f32 v152, v152
  v_mfma_f32_32x32x16_bf16 v[64:79], v[208:211], v[184:187], v[64:79]
  s_mov_b32 s11, 57344
  v_exp_f32 v153, v153
  v_perm_b32 v179, v151, v150, s38
  v_exp_f32 v154, v154
  v_exp_f32 v155, v155
  v_perm_b32 v180, v153, v152, s38
  v_exp_f32 v156, v156
  v_mfma_f32_32x32x16_bf16 v[64:79], v[212:215], v[188:191], v[64:79]
  buffer_load_dwordx4 v[120:123], v249, s[64:67], s11 offen
  v_exp_f32 v157, v157
  v_perm_b32 v181, v155, v154, s38
  v_exp_f32 v158, v158
  v_exp_f32 v159, v159
  v_perm_b32 v182, v157, v156, s38
  v_perm_b32 v183, v159, v158, s38
  s_waitcnt vmcnt(13)
  v_mfma_f32_32x32x16_bf16 v[144:159], v[216:219], v[16:19], 0
  v_exp_f32 v160, v160
  v_exp_f32 v161, v161
  v_exp_f32 v162, v162
  v_exp_f32 v163, v163
  v_perm_b32 v184, v161, v160, s38
  v_exp_f32 v164, v164
  v_mfma_f32_32x32x16_bf16 v[144:159], v[220:223], v[20:23], v[144:159]
  v_exp_f32 v165, v165
  v_perm_b32 v185, v163, v162, s38
  v_exp_f32 v166, v166
  v_exp_f32 v167, v167
  v_perm_b32 v186, v165, v164, s38
  v_exp_f32 v168, v168
  v_mfma_f32_32x32x16_bf16 v[80:95], v[208:211], v[176:179], v[80:95]
  s_mov_b32 s11, 86016
  v_exp_f32 v169, v169
  v_perm_b32 v187, v167, v166, s38
  v_exp_f32 v170, v170
  v_exp_f32 v171, v171
  v_perm_b32 v188, v169, v168, s38
  v_exp_f32 v172, v172
  v_mfma_f32_32x32x16_bf16 v[80:95], v[212:215], v[180:183], v[80:95]
  buffer_load_dwordx4 v[124:127], v249, s[64:67], s11 offen
  v_exp_f32 v173, v173
  v_perm_b32 v189, v171, v170, s38
  v_exp_f32 v174, v174
  v_exp_f32 v175, v175
  v_perm_b32 v190, v173, v172, s38
  v_perm_b32 v191, v175, v174, s38
  v_mfma_f32_32x32x16_bf16 v[160:175], v[216:219], v[24:27], 0
  v_exp_f32 v144, v144
  v_exp_f32 v145, v145
  v_exp_f32 v146, v146
  v_exp_f32 v147, v147
  v_perm_b32 v176, v145, v144, s38
  v_exp_f32 v148, v148
  v_mfma_f32_32x32x16_bf16 v[160:175], v[220:223], v[28:31], v[160:175]
  v_exp_f32 v149, v149
  v_perm_b32 v177, v147, v146, s38
  v_exp_f32 v150, v150
  v_exp_f32 v151, v151
  v_perm_b32 v178, v149, v148, s38
  v_exp_f32 v152, v152
  v_mfma_f32_32x32x16_bf16 v[96:111], v[208:211], v[184:187], v[96:111]
  s_mov_b32 s11, 114688
  v_exp_f32 v153, v153
  v_perm_b32 v179, v151, v150, s38
  v_exp_f32 v154, v154
  v_exp_f32 v155, v155
  v_perm_b32 v180, v153, v152, s38
  v_exp_f32 v156, v156
  v_mfma_f32_32x32x16_bf16 v[96:111], v[212:215], v[188:191], v[96:111]
  buffer_load_dwordx4 v[128:131], v249, s[64:67], s11 offen
  v_exp_f32 v157, v157
  v_perm_b32 v181, v155, v154, s38
  v_exp_f32 v158, v158
  v_exp_f32 v159, v159
  v_perm_b32 v182, v157, v156, s38
  v_perm_b32 v183, v159, v158, s38
  v_mfma_f32_32x32x16_bf16 v[144:159], v[216:219], v[32:35], 0
  v_exp_f32 v160, v160
  v_exp_f32 v161, v161
  v_exp_f32 v162, v162
  v_exp_f32 v163, v163
  v_perm_b32 v184, v161, v160, s38
  v_exp_f32 v164, v164
  v_mfma_f32_32x32x16_bf16 v[144:159], v[220:223], v[36:39], v[144:159]
  v_exp_f32 v165, v165
  v_perm_b32 v185, v163, v162, s38
  v_exp_f32 v166, v166
  v_exp_f32 v167, v167
  v_perm_b32 v186, v165, v164, s38
  v_exp_f32 v168, v168
  s_waitcnt vmcnt(13)
  v_mfma_f32_32x32x16_bf16 v[48:63], v[224:227], v[176:179], v[48:63]
  s_mov_b32 s11, 143360
  v_exp_f32 v169, v169
  v_perm_b32 v187, v167, v166, s38
  v_exp_f32 v170, v170
  v_exp_f32 v171, v171
  v_perm_b32 v188, v169, v168, s38
  v_exp_f32 v172, v172
  v_mfma_f32_32x32x16_bf16 v[48:63], v[228:231], v[180:183], v[48:63]
  buffer_load_dwordx4 v[132:135], v249, s[64:67], s11 offen
  v_exp_f32 v173, v173
  v_perm_b32 v189, v171, v170, s38
  v_exp_f32 v174, v174
  v_exp_f32 v175, v175
  v_perm_b32 v190, v173, v172, s38
  v_perm_b32 v191, v175, v174, s38
  v_mfma_f32_32x32x16_bf16 v[160:175], v[216:219], v[40:43], 0
  v_exp_f32 v144, v144
  v_exp_f32 v145, v145
  v_exp_f32 v146, v146
  v_exp_f32 v147, v147
  v_perm_b32 v176, v145, v144, s38
  v_exp_f32 v148, v148
  v_mfma_f32_32x32x16_bf16 v[160:175], v[220:223], v[44:47], v[160:175]
  ds_write_b128 v196, v[48:51] offset:0
  v_exp_f32 v149, v149
  v_perm_b32 v177, v147, v146, s38
  v_exp_f32 v150, v150
  v_exp_f32 v151, v151
  v_perm_b32 v178, v149, v148, s38
  v_exp_f32 v152, v152
  v_mfma_f32_32x32x16_bf16 v[64:79], v[224:227], v[184:187], v[64:79]
  s_mov_b32 s11, 172032
  ds_write_b128 v196, v[52:55] offset:1024
  ds_write_b128 v196, v[56:59] offset:2048
  v_exp_f32 v153, v153
  v_perm_b32 v179, v151, v150, s38
  v_exp_f32 v154, v154
  v_exp_f32 v155, v155
  v_perm_b32 v180, v153, v152, s38
  v_exp_f32 v156, v156
  v_mfma_f32_32x32x16_bf16 v[64:79], v[228:231], v[188:191], v[64:79]
  buffer_load_dwordx4 v[136:139], v249, s[64:67], s11 offen
  ds_write_b128 v196, v[60:63] offset:3072
  v_exp_f32 v157, v157
  v_perm_b32 v181, v155, v154, s38
  v_exp_f32 v158, v158
  v_exp_f32 v159, v159
  v_perm_b32 v182, v157, v156, s38
  v_perm_b32 v183, v159, v158, s38
  v_mfma_f32_32x32x16_bf16 v[80:95], v[224:227], v[176:179], v[80:95]
  v_exp_f32 v160, v160
  v_exp_f32 v161, v161
  v_exp_f32 v162, v162
  v_exp_f32 v163, v163
  v_perm_b32 v184, v161, v160, s38
  v_exp_f32 v164, v164
  v_mfma_f32_32x32x16_bf16 v[80:95], v[228:231], v[180:183], v[80:95]
  ds_write_b128 v197, v[64:67] offset:4096
  ds_write_b128 v197, v[68:71] offset:5120
  v_exp_f32 v165, v165
  v_perm_b32 v185, v163, v162, s38
  v_exp_f32 v166, v166
  v_exp_f32 v167, v167
  v_perm_b32 v186, v165, v164, s38
  v_exp_f32 v168, v168
  ds_write_b128 v197, v[72:75] offset:6144
  ds_write_b128 v197, v[76:79] offset:7168
  v_exp_f32 v169, v169
  v_perm_b32 v187, v167, v166, s38
  v_exp_f32 v170, v170
  v_exp_f32 v171, v171
  v_perm_b32 v188, v169, v168, s38
  v_exp_f32 v172, v172
  v_mfma_f32_32x32x16_bf16 v[96:111], v[224:227], v[184:187], v[96:111]
  ds_write_b128 v198, v[80:83] offset:8192
  ds_write_b128 v198, v[84:87] offset:9216
  ds_write_b128 v198, v[88:91] offset:10240
  ds_write_b128 v198, v[92:95] offset:11264
  v_exp_f32 v173, v173
  v_perm_b32 v189, v171, v170, s38
  v_exp_f32 v174, v174
  v_exp_f32 v175, v175
  v_perm_b32 v190, v173, v172, s38
  v_perm_b32 v191, v175, v174, s38
  s_setprio 3
  s_waitcnt lgkmcnt(0)
  v_mfma_f32_32x32x16_bf16 v[96:111], v[228:231], v[188:191], v[96:111]
  s_barrier
  ds_read_b128 v[144:147], v2 offset:0
  ds_read_b128 v[148:151], v2 offset:1024
  ds_read_b128 v[152:155], v2 offset:2048
  ds_read_b128 v[156:159], v2 offset:3072
  ds_read_b128 v[160:163], v2 offset:4096
  ds_read_b128 v[164:167], v2 offset:5120
  ds_read_b128 v[168:171], v2 offset:6144
  ds_read_b128 v[172:175], v2 offset:7168
  ds_read_b128 v[176:179], v2 offset:8192
  ds_read_b128 v[180:183], v2 offset:9216
  ds_read_b128 v[184:187], v2 offset:10240
  ds_read_b128 v[188:191], v2 offset:11264
  s_waitcnt lgkmcnt(4)
  v_add_f32 v144, v144, v160
  v_add_f32 v145, v145, v161
  v_add_f32 v146, v146, v162
  v_add_f32 v147, v147, v163
  v_add_f32 v148, v148, v164
  v_add_f32 v149, v149, v165
  v_add_f32 v150, v150, v166
  v_add_f32 v151, v151, v167
  v_add_f32 v152, v152, v168
  v_add_f32 v153, v153, v169
  v_add_f32 v154, v154, v170
  v_add_f32 v155, v155, v171
  v_add_f32 v156, v156, v172
  v_add_f32 v157, v157, v173
  v_add_f32 v158, v158, v174
  v_add_f32 v159, v159, v175
  s_waitcnt lgkmcnt(0)
  v_add_f32 v144, v144, v176
  v_add_f32 v145, v145, v177
  v_add_f32 v146, v146, v178
  v_add_f32 v147, v147, v179
  v_add_f32 v148, v148, v180
  v_add_f32 v149, v149, v181
  v_add_f32 v150, v150, v182
  v_add_f32 v151, v151, v183
  v_add_f32 v152, v152, v184
  v_add_f32 v153, v153, v185
  v_add_f32 v154, v154, v186
  v_add_f32 v155, v155, v187
  v_add_f32 v156, v156, v188
  v_add_f32 v157, v157, v189
  v_add_f32 v158, v158, v190
  v_add_f32 v159, v159, v191
  v_add_f32 v108, v108, v156
  v_add_f32 v96, v96, v144
  v_mov_b32 v208, v108
  v_mov_b32 v209, v108
  v_add_f32 v97, v97, v145
  v_add_f32 v98, v98, v146
  v_add_f32 v99, v99, v147
  v_permlane32_swap_b32 v208, v209
  v_add_f32 v100, v100, v148
  v_add_f32 v101, v101, v149
  v_add_f32 v102, v102, v150
  v_rcp_f32 v208, v209
  v_add_f32 v103, v103, v151
  v_add_f32 v104, v104, v152
  v_add_f32 v105, v105, v153
  v_add_f32 v106, v106, v154
  v_add_f32 v107, v107, v155
  v_add_f32 v109, v109, v157
  v_add_f32 v110, v110, v158
  v_add_f32 v111, v111, v159
  s_load_dwordx8 s[16:23], s[44:45], s100 glc
  v_mul_f32 v96, v96, v208
  v_mul_f32 v97, v97, v208
  v_mul_f32 v98, v98, v208
  v_mul_f32 v99, v99, v208
  v_mul_f32 v100, v100, v208
  v_mul_f32 v101, v101, v208
  v_mul_f32 v102, v102, v208
  v_mul_f32 v103, v103, v208
  v_mul_f32 v104, v104, v208
  v_mul_f32 v105, v105, v208
  v_mul_f32 v106, v106, v208
  v_mul_f32 v107, v107, v208
  v_mul_f32 v108, v108, v208
  v_mul_f32 v109, v109, v208
  v_mul_f32 v110, v110, v208
  v_mul_f32 v111, v111, v208
  v_cvt_pk_bf16_f32 v200, v96, v97
  v_cvt_pk_bf16_f32 v201, v98, v99
  v_cvt_pk_bf16_f32 v202, v100, v101
  v_cvt_pk_bf16_f32 v203, v102, v103
  v_cvt_pk_bf16_f32 v204, v104, v105
  v_cvt_pk_bf16_f32 v205, v106, v107
  v_cvt_pk_bf16_f32 v206, v108, v109
  v_cvt_pk_bf16_f32 v207, v110, v111
  s_mov_b32 exec_lo, 0
  v_mov_b32 v206, 0
  v_mov_b32 v207, 0
  s_mov_b32 exec_lo, -1
  s_mov_b32 s12, 0
  s_cmp_lg_u32 s73, 0
  s_cbranch_scc1 L_skip_65
  buffer_store_dwordx4 v[200:203], v15, s[56:59], s42 offen sc1
  buffer_store_dwordx4 v[204:207], v15, s[56:59], s42 offen offset:1024 sc1
  s_mov_b32 s9, 0x3f803f80
  v_mov_b32 v210, 0
  v_dot2_f32_bf16 v210, v200, s9, v210
  v_dot2_f32_bf16 v210, v201, s9, v210
  v_dot2_f32_bf16 v210, v202, s9, v210
  v_dot2_f32_bf16 v210, v203, s9, v210
  v_dot2_f32_bf16 v210, v204, s9, v210
  v_dot2_f32_bf16 v210, v205, s9, v210
  v_dot2_f32_bf16 v210, v206, s9, v210
  v_dot2_f32_bf16 v210, v207, s9, v210
  s_mov_b32 s12, 0x5f800000
  v_mov_b32 v211, 0x207
  v_cmp_nle_f32 vcc, 0x1f800000, v209
  v_cmp_nge_f32 s[10:11], s12, v209
  s_nop 0
  s_or_b64 s[10:11], s[10:11], vcc
  v_cmp_class_f32 vcc, v210, v211
  s_nop 0
  s_or_b64 s[10:11], s[10:11], vcc
  s_cmp_lg_u64 s[10:11], 0
  s_cselect_b32 s12, 1, 0
  s_andn2_b32 s12, s12, s72
  s_cbranch_scc1 L_skip_65
  s_waitcnt vmcnt(0)
  s_mov_b64 exec, 0x7f
  buffer_store_dword v199, v7, s[56:59], s43 offen sc1
  s_mov_b64 exec, -1
  s_mov_b32 s73, 1
L_nopub_64:
  v_mov_b32 v210, s12
  ds_write_b32 v4, v210 offset:3588
  s_waitcnt lgkmcnt(0)
  s_barrier
  ds_read_b32 v212, v248 offset:3588
  ds_read_b32 v213, v248 offset:3604
  ds_read_b32 v214, v248 offset:3620
  ds_read_b32 v215, v248 offset:3636
  s_waitcnt lgkmcnt(0)
  v_or3_b32 v212, v212, v213, v214
  v_or_b32 v212, v212, v215
  v_cmp_ne_u32 vcc, 0, v212
  s_nop 0
  s_cbranch_vccnz L_fallback_66
  s_cmp_eq_u32 s7, 7
  s_cbranch_scc1 L_end_concat_heads__ssm_conv_s4d__grouped_kv_mqa__prompt_kernel
  s_mov_b32 s47, 1048576
L_wo_67:
  s_cmp_eq_u32 s101, 0
  s_cselect_b64 s[16:17], s[40:41], s[16:17]
  s_xor_b64 s[16:17], s[16:17], s[40:41]
  s_cmp_eq_u32 s101, 1
  s_cselect_b64 s[18:19], s[40:41], s[18:19]
  s_xor_b64 s[18:19], s[18:19], s[40:41]
  s_cmp_eq_u32 s101, 2
  s_cselect_b64 s[20:21], s[40:41], s[20:21]
  s_xor_b64 s[20:21], s[20:21], s[40:41]
  s_cmp_eq_u32 s101, 3
  s_cselect_b64 s[22:23], s[40:41], s[22:23]
  s_xor_b64 s[22:23], s[22:23], s[40:41]
  s_or_b64 s[16:17], s[16:17], s[18:19]
  s_or_b64 s[20:21], s[20:21], s[22:23]
  s_or_b64 s[18:19], s[16:17], s[20:21]
  s_cbranch_scc0 L_wall_68
  s_load_dwordx8 s[16:23], s[44:45], s100 glc
  s_sub_u32 s47, s47, 1
  s_cmp_gt_i32 s47, 0
  s_waitcnt lgkmcnt(0)
  s_cbranch_scc1 L_wo_67
L_wall_68:
  buffer_load_dwordx4 v[16:19], v15, s[56:59], s96 offen offset:0 sc1
  ds_write_b128 v1, v[112:115] offset:23552
  buffer_load_dwordx4 v[20:23], v15, s[56:59], s96 offen offset:1024 sc1
  ds_write_b128 v1, v[116:119] offset:27648
  buffer_load_dwordx4 v[24:27], v15, s[56:59], s96 offen offset:2048 sc1
  ds_write_b128 v1, v[120:123] offset:31744
  buffer_load_dwordx4 v[28:31], v15, s[56:59], s96 offen offset:3072 sc1
  ds_write_b128 v1, v[124:127] offset:35840
  s_add_u32 s96, s96, 4096
  buffer_load_dwordx4 v[32:35], v15, s[56:59], s96 offen offset:0 sc1
  ds_write_b128 v1, v[128:131] offset:39936
  buffer_load_dwordx4 v[36:39], v15, s[56:59], s96 offen offset:1024 sc1
  ds_write_b128 v1, v[132:135] offset:44032
  buffer_load_dwordx4 v[40:43], v15, s[56:59], s96 offen offset:2048 sc1
  ds_write_b128 v1, v[136:139] offset:48128
  buffer_load_dwordx4 v[44:47], v15, s[56:59], s96 offen offset:3072 sc1
  buffer_load_dwordx4 v[48:51], v15, s[56:59], s97 offen offset:0 sc1
  buffer_load_dwordx4 v[52:55], v15, s[56:59], s97 offen offset:1024 sc1
  buffer_load_dwordx4 v[56:59], v15, s[56:59], s97 offen offset:2048 sc1
  buffer_load_dwordx4 v[60:63], v15, s[56:59], s97 offen offset:3072 sc1
  s_add_u32 s97, s97, 4096
  buffer_load_dwordx4 v[64:67], v15, s[56:59], s97 offen offset:0 sc1
  buffer_load_dwordx4 v[68:71], v15, s[56:59], s97 offen offset:1024 sc1
  buffer_load_dwordx4 v[72:75], v15, s[56:59], s97 offen offset:2048 sc1
  buffer_load_dwordx4 v[76:79], v15, s[56:59], s97 offen offset:3072 sc1
  s_waitcnt lgkmcnt(0)
  s_barrier
  ds_read_b64_tr_b16 v[144:145], v14 offset:0
  ds_read_b64_tr_b16 v[146:147], v14 offset:1024
  ds_read_b64_tr_b16 v[148:149], v13 offset:0
  ds_read_b64_tr_b16 v[150:151], v13 offset:1024
  ds_read_b64_tr_b16 v[152:153], v14 offset:2048
  ds_read_b64_tr_b16 v[154:155], v14 offset:3072
  ds_read_b64_tr_b16 v[156:157], v13 offset:2048
  ds_read_b64_tr_b16 v[158:159], v13 offset:3072
  ds_read_b64_tr_b16 v[160:161], v14 offset:3584
  ds_read_b64_tr_b16 v[162:163], v14 offset:4608
  ds_read_b64_tr_b16 v[164:165], v13 offset:3584
  ds_read_b64_tr_b16 v[166:167], v13 offset:4608
  ds_read_b64_tr_b16 v[168:169], v14 offset:5632
  ds_read_b64_tr_b16 v[170:171], v14 offset:6656
  ds_read_b64_tr_b16 v[172:173], v13 offset:5632
  ds_read_b64_tr_b16 v[174:175], v13 offset:6656
  s_waitcnt vmcnt(15) lgkmcnt(12)
  v_mfma_f32_32x32x16_bf16 v[96:111], v[148:151], v[16:19], 0
  v_mfma_f32_32x32x16_bf16 v[80:95], v[144:147], v[16:19], 0
  ds_read_b64_tr_b16 v[144:145], v14 offset:7168
  ds_read_b64_tr_b16 v[146:147], v14 offset:8192
  ds_read_b64_tr_b16 v[148:149], v13 offset:7168
  ds_read_b64_tr_b16 v[150:151], v13 offset:8192
  s_waitcnt vmcnt(14) lgkmcnt(12)
  v_mfma_f32_32x32x16_bf16 v[96:111], v[156:159], v[20:23], v[96:111]
  v_mfma_f32_32x32x16_bf16 v[80:95], v[152:155], v[20:23], v[80:95]
  ds_read_b64_tr_b16 v[152:153], v14 offset:9216
  ds_read_b64_tr_b16 v[154:155], v14 offset:10240
  ds_read_b64_tr_b16 v[156:157], v13 offset:9216
  ds_read_b64_tr_b16 v[158:159], v13 offset:10240
  s_waitcnt vmcnt(13) lgkmcnt(12)
  v_mfma_f32_32x32x16_bf16 v[96:111], v[164:167], v[24:27], v[96:111]
  v_mfma_f32_32x32x16_bf16 v[80:95], v[160:163], v[24:27], v[80:95]
  ds_read_b64_tr_b16 v[160:161], v14 offset:10752
  ds_read_b64_tr_b16 v[162:163], v14 offset:11776
  ds_read_b64_tr_b16 v[164:165], v13 offset:10752
  ds_read_b64_tr_b16 v[166:167], v13 offset:11776
  s_waitcnt vmcnt(12) lgkmcnt(12)
  v_mfma_f32_32x32x16_bf16 v[96:111], v[172:175], v[28:31], v[96:111]
  v_mfma_f32_32x32x16_bf16 v[80:95], v[168:171], v[28:31], v[80:95]
  ds_read_b64_tr_b16 v[168:169], v14 offset:12800
  ds_read_b64_tr_b16 v[170:171], v14 offset:13824
  ds_read_b64_tr_b16 v[172:173], v13 offset:12800
  ds_read_b64_tr_b16 v[174:175], v13 offset:13824
  s_waitcnt vmcnt(11) lgkmcnt(12)
  v_mfma_f32_32x32x16_bf16 v[96:111], v[148:151], v[32:35], v[96:111]
  v_mfma_f32_32x32x16_bf16 v[80:95], v[144:147], v[32:35], v[80:95]
  ds_read_b64_tr_b16 v[144:145], v12 offset:0
  ds_read_b64_tr_b16 v[146:147], v12 offset:1024
  ds_read_b64_tr_b16 v[148:149], v11 offset:0
  ds_read_b64_tr_b16 v[150:151], v11 offset:1024
  s_waitcnt vmcnt(10) lgkmcnt(12)
  v_mfma_f32_32x32x16_bf16 v[96:111], v[156:159], v[36:39], v[96:111]
  v_mfma_f32_32x32x16_bf16 v[80:95], v[152:155], v[36:39], v[80:95]
  ds_read_b64_tr_b16 v[152:153], v12 offset:2048
  ds_read_b64_tr_b16 v[154:155], v12 offset:3072
  ds_read_b64_tr_b16 v[156:157], v11 offset:2048
  ds_read_b64_tr_b16 v[158:159], v11 offset:3072
  s_waitcnt vmcnt(9) lgkmcnt(12)
  v_mfma_f32_32x32x16_bf16 v[96:111], v[164:167], v[40:43], v[96:111]
  v_mfma_f32_32x32x16_bf16 v[80:95], v[160:163], v[40:43], v[80:95]
  ds_read_b64_tr_b16 v[160:161], v12 offset:3584
  ds_read_b64_tr_b16 v[162:163], v12 offset:4608
  ds_read_b64_tr_b16 v[164:165], v11 offset:3584
  ds_read_b64_tr_b16 v[166:167], v11 offset:4608
  s_waitcnt vmcnt(8) lgkmcnt(12)
  v_mfma_f32_32x32x16_bf16 v[96:111], v[172:175], v[44:47], v[96:111]
  v_mfma_f32_32x32x16_bf16 v[80:95], v[168:171], v[44:47], v[80:95]
  ds_read_b64_tr_b16 v[168:169], v12 offset:5632
  ds_read_b64_tr_b16 v[170:171], v12 offset:6656
  ds_read_b64_tr_b16 v[172:173], v11 offset:5632
  ds_read_b64_tr_b16 v[174:175], v11 offset:6656
  s_waitcnt vmcnt(7) lgkmcnt(12)
  v_mfma_f32_32x32x16_bf16 v[96:111], v[148:151], v[48:51], v[96:111]
  v_mfma_f32_32x32x16_bf16 v[80:95], v[144:147], v[48:51], v[80:95]
  ds_read_b64_tr_b16 v[144:145], v12 offset:7168
  ds_read_b64_tr_b16 v[146:147], v12 offset:8192
  ds_read_b64_tr_b16 v[148:149], v11 offset:7168
  ds_read_b64_tr_b16 v[150:151], v11 offset:8192
  s_waitcnt vmcnt(6) lgkmcnt(12)
  v_mfma_f32_32x32x16_bf16 v[96:111], v[156:159], v[52:55], v[96:111]
  v_mfma_f32_32x32x16_bf16 v[80:95], v[152:155], v[52:55], v[80:95]
  ds_read_b64_tr_b16 v[152:153], v12 offset:9216
  ds_read_b64_tr_b16 v[154:155], v12 offset:10240
  ds_read_b64_tr_b16 v[156:157], v11 offset:9216
  ds_read_b64_tr_b16 v[158:159], v11 offset:10240
  s_waitcnt vmcnt(5) lgkmcnt(12)
  v_mfma_f32_32x32x16_bf16 v[96:111], v[164:167], v[56:59], v[96:111]
  v_mfma_f32_32x32x16_bf16 v[80:95], v[160:163], v[56:59], v[80:95]
  ds_read_b64_tr_b16 v[160:161], v12 offset:10752
  ds_read_b64_tr_b16 v[162:163], v12 offset:11776
  ds_read_b64_tr_b16 v[164:165], v11 offset:10752
  ds_read_b64_tr_b16 v[166:167], v11 offset:11776
  s_waitcnt vmcnt(4) lgkmcnt(12)
  v_mfma_f32_32x32x16_bf16 v[96:111], v[172:175], v[60:63], v[96:111]
  v_mfma_f32_32x32x16_bf16 v[80:95], v[168:171], v[60:63], v[80:95]
  ds_read_b64_tr_b16 v[168:169], v12 offset:12800
  ds_read_b64_tr_b16 v[170:171], v12 offset:13824
  ds_read_b64_tr_b16 v[172:173], v11 offset:12800
  ds_read_b64_tr_b16 v[174:175], v11 offset:13824
  s_waitcnt vmcnt(3) lgkmcnt(12)
  v_mfma_f32_32x32x16_bf16 v[96:111], v[148:151], v[64:67], v[96:111]
  v_mfma_f32_32x32x16_bf16 v[80:95], v[144:147], v[64:67], v[80:95]
  s_waitcnt vmcnt(2) lgkmcnt(8)
  v_mfma_f32_32x32x16_bf16 v[96:111], v[156:159], v[68:71], v[96:111]
  v_mfma_f32_32x32x16_bf16 v[80:95], v[152:155], v[68:71], v[80:95]
  s_waitcnt vmcnt(1) lgkmcnt(4)
  v_mfma_f32_32x32x16_bf16 v[96:111], v[164:167], v[72:75], v[96:111]
  v_mfma_f32_32x32x16_bf16 v[80:95], v[160:163], v[72:75], v[80:95]
  s_waitcnt vmcnt(0) lgkmcnt(0)
  v_mfma_f32_32x32x16_bf16 v[96:111], v[172:175], v[76:79], v[96:111]
  v_mfma_f32_32x32x16_bf16 v[80:95], v[168:171], v[76:79], v[80:95]
  s_nop 10
  ds_write_b128 v5, v[96:99] offset:0
  ds_write_b128 v5, v[100:103] offset:1024
  ds_write_b128 v5, v[104:107] offset:2048
  ds_write_b128 v5, v[108:111] offset:3072
  s_waitcnt lgkmcnt(0)
  s_barrier
  ds_read_b128 v[16:19], v6 offset:0
  ds_read_b128 v[20:23], v6 offset:1024
  ds_read_b128 v[24:27], v6 offset:2048
  ds_read_b128 v[28:31], v6 offset:3072
  s_waitcnt lgkmcnt(0)
  v_add_f32 v80, v80, v16
  v_add_f32 v81, v81, v17
  v_add_f32 v82, v82, v18
  v_add_f32 v83, v83, v19
  v_add_f32 v84, v84, v20
  v_add_f32 v85, v85, v21
  v_add_f32 v86, v86, v22
  v_add_f32 v87, v87, v23
  v_add_f32 v88, v88, v24
  v_add_f32 v89, v89, v25
  v_add_f32 v90, v90, v26
  v_add_f32 v91, v91, v27
  v_add_f32 v92, v92, v28
  v_add_f32 v93, v93, v29
  v_add_f32 v94, v94, v30
  v_add_f32 v95, v95, v31
  v_cvt_pk_bf16_f32 v32, v80, v81
  v_cvt_pk_bf16_f32 v33, v82, v83
  v_cvt_pk_bf16_f32 v34, v84, v85
  v_cvt_pk_bf16_f32 v35, v86, v87
  v_cvt_pk_bf16_f32 v36, v88, v89
  v_cvt_pk_bf16_f32 v37, v90, v91
  v_cvt_pk_bf16_f32 v38, v92, v93
  v_cvt_pk_bf16_f32 v39, v94, v95
  v_permlane32_swap_b32 v32, v34
  v_permlane32_swap_b32 v33, v35
  v_permlane32_swap_b32 v36, v38
  v_permlane32_swap_b32 v37, v39
  ds_write_b128 v9, v[32:35]
  ds_write_b128 v9, v[36:39] offset:32
  s_waitcnt lgkmcnt(0)
  s_barrier
  ds_read_b128 v[16:19], v10
  ds_read_b128 v[20:23], v10 offset:1152
  s_waitcnt lgkmcnt(1)
  buffer_store_dwordx4 v[16:19], v8, s[60:63], s98 offen sc1
  s_waitcnt lgkmcnt(0)
  buffer_store_dwordx4 v[20:23], v8, s[60:63], s99 offen sc1
  s_endpgm
L_kvspin_58:
  s_mov_b32 s47, 1048576
L_kvs_74:
  s_sleep 2
  s_sub_u32 s47, s47, 1
  s_cmp_gt_i32 s47, 0
  s_cbranch_scc0 L_kvback_59
  s_load_dwordx8 s[16:23], s[44:45], s8 glc
  s_load_dwordx8 s[24:31], s[44:45], s9 glc
  s_waitcnt lgkmcnt(0)
  s_cmp_eq_u64 s[16:17], s[40:41]
  s_cbranch_scc0 L_kvs_74
  s_cmp_eq_u64 s[18:19], s[40:41]
  s_cbranch_scc0 L_kvs_74
  s_cmp_eq_u64 s[20:21], s[40:41]
  s_cbranch_scc0 L_kvs_74
  s_cmp_eq_u64 s[22:23], s[40:41]
  s_cbranch_scc0 L_kvs_74
  s_cmp_eq_u64 s[24:25], s[40:41]
  s_cbranch_scc0 L_kvs_74
  s_cmp_eq_u64 s[26:27], s[40:41]
  s_cbranch_scc0 L_kvs_74
  s_cmp_eq_u64 s[28:29], s[40:41]
  s_cbranch_scc0 L_kvs_74
  s_cmp_eq_u64 s[30:31], s[40:41]
  s_cbranch_scc0 L_kvs_74
  s_branch L_kvback_59
L_kvspin_61:
  s_mov_b32 s47, 1048576
L_kvs_76:
  s_sleep 2
  s_sub_u32 s47, s47, 1
  s_cmp_gt_i32 s47, 0
  s_cbranch_scc0 L_kvback_62
  s_load_dwordx8 s[16:23], s[44:45], s8 glc
  s_load_dwordx8 s[24:31], s[44:45], s9 glc
  s_waitcnt lgkmcnt(0)
  s_cmp_eq_u64 s[16:17], s[40:41]
  s_cbranch_scc0 L_kvs_76
  s_cmp_eq_u64 s[18:19], s[40:41]
  s_cbranch_scc0 L_kvs_76
  s_cmp_eq_u64 s[20:21], s[40:41]
  s_cbranch_scc0 L_kvs_76
  s_cmp_eq_u64 s[22:23], s[40:41]
  s_cbranch_scc0 L_kvs_76
  s_cmp_eq_u64 s[24:25], s[40:41]
  s_cbranch_scc0 L_kvs_76
  s_cmp_eq_u64 s[26:27], s[40:41]
  s_cbranch_scc0 L_kvs_76
  s_cmp_eq_u64 s[28:29], s[40:41]
  s_cbranch_scc0 L_kvs_76
  s_cmp_eq_u64 s[30:31], s[40:41]
  s_cbranch_scc0 L_kvs_76
  s_branch L_kvback_62
L_skip_65:
  s_waitcnt vmcnt(0)
  s_branch L_nopub_64
L_fallback_66:
  s_barrier
  s_mov_b32 s72, 1
  s_mov_b32 s70, 16
  s_mov_b32 s68, s37
  v_mov_b32 v240, 0xff800000
  v_mov_b32 v241, 0xff800000
  v_mov_b32 v242, 0xff800000
  v_mov_b32 v243, 0xff800000
L_fbl_73:
  buffer_load_dwordx4 v[112:115], v15, s[56:59], s68 offen sc1
  buffer_load_dwordx4 v[116:119], v15, s[56:59], s68 offen offset:1024 sc1
  s_bitcmp1_b32 s70, 0
  s_cselect_b32 s8, 7, 1
  s_lshl_b32 s8, s8, 12
  s_add_u32 s68, s68, s8
  s_waitcnt vmcnt(0)
  v_mfma_f32_32x32x16_bf16 v[144:159], v[112:115], v[16:19], 0
  v_mfma_f32_32x32x16_bf16 v[144:159], v[116:119], v[20:23], v[144:159]
  s_nop 11
  v_max3_f32 v240, v240, v144, v145
  v_max3_f32 v240, v240, v146, v147
  v_max3_f32 v240, v240, v148, v149
  v_max3_f32 v240, v240, v150, v151
  v_max3_f32 v240, v240, v152, v153
  v_max3_f32 v240, v240, v154, v155
  v_max3_f32 v240, v240, v156, v157
  v_max3_f32 v240, v240, v158, v159
  v_mfma_f32_32x32x16_bf16 v[144:159], v[112:115], v[24:27], 0
  v_mfma_f32_32x32x16_bf16 v[144:159], v[116:119], v[28:31], v[144:159]
  s_nop 11
  v_max3_f32 v241, v241, v144, v145
  v_max3_f32 v241, v241, v146, v147
  v_max3_f32 v241, v241, v148, v149
  v_max3_f32 v241, v241, v150, v151
  v_max3_f32 v241, v241, v152, v153
  v_max3_f32 v241, v241, v154, v155
  v_max3_f32 v241, v241, v156, v157
  v_max3_f32 v241, v241, v158, v159
  v_mfma_f32_32x32x16_bf16 v[144:159], v[112:115], v[32:35], 0
  v_mfma_f32_32x32x16_bf16 v[144:159], v[116:119], v[36:39], v[144:159]
  s_nop 11
  v_max3_f32 v242, v242, v144, v145
  v_max3_f32 v242, v242, v146, v147
  v_max3_f32 v242, v242, v148, v149
  v_max3_f32 v242, v242, v150, v151
  v_max3_f32 v242, v242, v152, v153
  v_max3_f32 v242, v242, v154, v155
  v_max3_f32 v242, v242, v156, v157
  v_max3_f32 v242, v242, v158, v159
  v_mfma_f32_32x32x16_bf16 v[144:159], v[112:115], v[40:43], 0
  v_mfma_f32_32x32x16_bf16 v[144:159], v[116:119], v[44:47], v[144:159]
  s_nop 11
  v_max3_f32 v243, v243, v144, v145
  v_max3_f32 v243, v243, v146, v147
  v_max3_f32 v243, v243, v148, v149
  v_max3_f32 v243, v243, v150, v151
  v_max3_f32 v243, v243, v152, v153
  v_max3_f32 v243, v243, v154, v155
  v_max3_f32 v243, v243, v156, v157
  v_max3_f32 v243, v243, v158, v159
  s_sub_u32 s70, s70, 1
  s_cmp_lg_u32 s70, 0
  s_cbranch_scc1 L_fbl_73
  s_lshl_b32 s8, s3, 8
  v_lshl_add_u32 v244, v0, 2, s8
  v_lshlrev_b32 v245, 2, v0
  v_mov_b32 v246, v240
  v_mov_b32 v247, v240
  s_nop 1
  v_permlane32_swap_b32 v246, v247
  v_max_f32 v240, v246, v247
  s_add_u32 s8, s3, 1
  s_and_b32 s8, s8, 3
  s_lshl_b32 s8, s8, 10
  v_add_u32 v246, s8, v244
  v_add_u32 v236, s8, v245
  ds_write_b32 v246, v240 offset:1024
  v_mov_b32 v246, v241
  v_mov_b32 v247, v241
  s_nop 1
  v_permlane32_swap_b32 v246, v247
  v_max_f32 v241, v246, v247
  s_add_u32 s8, s3, 2
  s_and_b32 s8, s8, 3
  s_lshl_b32 s8, s8, 10
  v_add_u32 v246, s8, v244
  v_add_u32 v237, s8, v245
  ds_write_b32 v246, v241 offset:1024
  v_mov_b32 v246, v242
  v_mov_b32 v247, v242
  s_nop 1
  v_permlane32_swap_b32 v246, v247
  v_max_f32 v242, v246, v247
  s_add_u32 s8, s3, 3
  s_and_b32 s8, s8, 3
  s_lshl_b32 s8, s8, 10
  v_add_u32 v246, s8, v244
  v_add_u32 v238, s8, v245
  ds_write_b32 v246, v242 offset:1024
  v_mov_b32 v246, v243
  v_mov_b32 v247, v243
  s_nop 1
  v_permlane32_swap_b32 v246, v247
  v_max_f32 v243, v246, v247
  s_add_u32 s8, s3, 4
  s_and_b32 s8, s8, 3
  s_lshl_b32 s8, s8, 10
  v_add_u32 v246, s8, v244
  v_add_u32 v239, s8, v245
  ds_write_b32 v246, v243 offset:1024
  s_waitcnt lgkmcnt(0)
  s_barrier
  ds_read2st64_b32 v[246:247], v236 offset0:4 offset1:5
  ds_read2st64_b32 v[250:251], v236 offset0:6 offset1:7
  s_waitcnt lgkmcnt(0)
  v_max3_f32 v246, v246, v247, v250
  v_max_f32 v246, v246, v251
  v_xor_b32 v246, 0x80000000, v246
  v_and_b32 v247, 0xffff0000, v246
  v_sub_f32 v246, v246, v247
  v_and_b32 v250, 0xffff0000, v246
  v_sub_f32 v246, v246, v250
  s_mov_b32 exec_lo, 0
  v_lshrrev_b32 v247, 16, v247
  v_or_b32 v22, v247, v250
  v_lshrrev_b32 v23, 16, v246
  s_mov_b32 exec_lo, -1
  ds_read2st64_b32 v[246:247], v237 offset0:4 offset1:5
  ds_read2st64_b32 v[250:251], v237 offset0:6 offset1:7
  s_waitcnt lgkmcnt(0)
  v_max3_f32 v246, v246, v247, v250
  v_max_f32 v246, v246, v251
  v_xor_b32 v246, 0x80000000, v246
  v_and_b32 v247, 0xffff0000, v246
  v_sub_f32 v246, v246, v247
  v_and_b32 v250, 0xffff0000, v246
  v_sub_f32 v246, v246, v250
  s_mov_b32 exec_lo, 0
  v_lshrrev_b32 v247, 16, v247
  v_or_b32 v30, v247, v250
  v_lshrrev_b32 v31, 16, v246
  s_mov_b32 exec_lo, -1
  ds_read2st64_b32 v[246:247], v238 offset0:4 offset1:5
  ds_read2st64_b32 v[250:251], v238 offset0:6 offset1:7
  s_waitcnt lgkmcnt(0)
  v_max3_f32 v246, v246, v247, v250
  v_max_f32 v246, v246, v251
  v_xor_b32 v246, 0x80000000, v246
  v_and_b32 v247, 0xffff0000, v246
  v_sub_f32 v246, v246, v247
  v_and_b32 v250, 0xffff0000, v246
  v_sub_f32 v246, v246, v250
  s_mov_b32 exec_lo, 0
  v_lshrrev_b32 v247, 16, v247
  v_or_b32 v38, v247, v250
  v_lshrrev_b32 v39, 16, v246
  s_mov_b32 exec_lo, -1
  ds_read2st64_b32 v[246:247], v239 offset0:4 offset1:5
  ds_read2st64_b32 v[250:251], v239 offset0:6 offset1:7
  s_waitcnt lgkmcnt(0)
  v_max3_f32 v246, v246, v247, v250
  v_max_f32 v246, v246, v251
  v_xor_b32 v246, 0x80000000, v246
  v_and_b32 v247, 0xffff0000, v246
  v_sub_f32 v246, v246, v247
  v_and_b32 v250, 0xffff0000, v246
  v_sub_f32 v246, v246, v250
  s_mov_b32 exec_lo, 0
  v_lshrrev_b32 v247, 16, v247
  v_or_b32 v46, v247, v250
  v_lshrrev_b32 v47, 16, v246
  s_mov_b32 exec_lo, -1
  v_mov_b32 v48, 0
  v_mov_b32 v49, 0
  v_mov_b32 v50, 0
  v_mov_b32 v51, 0
  v_mov_b32 v52, 0
  v_mov_b32 v53, 0
  v_mov_b32 v54, 0
  v_mov_b32 v55, 0
  v_mov_b32 v56, 0
  v_mov_b32 v57, 0
  v_mov_b32 v58, 0
  v_mov_b32 v59, 0
  v_mov_b32 v60, 0
  v_mov_b32 v61, 0
  v_mov_b32 v62, 0
  v_mov_b32 v63, 0
  v_mov_b32 v64, 0
  v_mov_b32 v65, 0
  v_mov_b32 v66, 0
  v_mov_b32 v67, 0
  v_mov_b32 v68, 0
  v_mov_b32 v69, 0
  v_mov_b32 v70, 0
  v_mov_b32 v71, 0
  v_mov_b32 v72, 0
  v_mov_b32 v73, 0
  v_mov_b32 v74, 0
  v_mov_b32 v75, 0
  v_mov_b32 v76, 0
  v_mov_b32 v77, 0
  v_mov_b32 v78, 0
  v_mov_b32 v79, 0
  v_mov_b32 v80, 0
  v_mov_b32 v81, 0
  v_mov_b32 v82, 0
  v_mov_b32 v83, 0
  v_mov_b32 v84, 0
  v_mov_b32 v85, 0
  v_mov_b32 v86, 0
  v_mov_b32 v87, 0
  v_mov_b32 v88, 0
  v_mov_b32 v89, 0
  v_mov_b32 v90, 0
  v_mov_b32 v91, 0
  v_mov_b32 v92, 0
  v_mov_b32 v93, 0
  v_mov_b32 v94, 0
  v_mov_b32 v95, 0
  v_mov_b32 v96, 0
  v_mov_b32 v97, 0
  v_mov_b32 v98, 0
  v_mov_b32 v99, 0
  v_mov_b32 v100, 0
  v_mov_b32 v101, 0
  v_mov_b32 v102, 0
  v_mov_b32 v103, 0
  v_mov_b32 v104, 0
  v_mov_b32 v105, 0
  v_mov_b32 v106, 0
  v_mov_b32 v107, 0
  v_mov_b32 v108, 0
  v_mov_b32 v109, 0
  v_mov_b32 v110, 0
  v_mov_b32 v111, 0
  v_mov_b32 v184, 0
  v_mov_b32 v185, 0
  v_mov_b32 v186, 0
  v_mov_b32 v187, 0
  v_mov_b32 v188, 0
  v_mov_b32 v189, 0
  v_mov_b32 v190, 0
  v_mov_b32 v191, 0
  v_mov_b32 v224, 0
  v_mov_b32 v225, 0
  v_mov_b32 v226, 0
  v_mov_b32 v227, 0
  v_mov_b32 v228, 0
  v_mov_b32 v229, 0
  v_mov_b32 v230, 0
  v_mov_b32 v231, 0
  s_barrier
  s_branch L_again_57
  s_endpgm
L_end_concat_heads__ssm_conv_s4d__grouped_kv_mqa__prompt_kernel:
  s_endpgm
.p2align 6
.type L_table,@object
L_table:
.long 0,144,288,432,8,152,296,440,16,160,304,448,24,168,312,456
.long 32,176,320,464,40,184,328,472,48,192,336,480,56,200,344,488
.long 64,208,352,496,72,216,360,504,80,224,368,512,88,232,376,520
.long 96,240,384,528,104,248,392,536,112,256,400,544,120,264,408,552
.long 1152,1152,1296,1440,1160,1160,1304,1448,1168,1168,1312,1456,1176,1176,1320,1464
.long 1184,1184,1328,1472,1192,1192,1336,1480,1200,1200,1344,1488,1208,1208,1352,1496
.long 1216,1216,1360,1504,1224,1224,1368,1512,1232,1232,1376,1520,1240,1240,1384,1528
.long 1248,1248,1392,1536,1256,1256,1400,1544,1264,1264,1408,1552,1272,1272,1416,1560
.long 1728,1728,1728,1872,1736,1736,1736,1880,1744,1744,1744,1888,1752,1752,1752,1896
.long 1760,1760,1760,1904,1768,1768,1768,1912,1776,1776,1776,1920,1784,1784,1784,1928
.long 1792,1792,1792,1936,1800,1800,1800,1944,1808,1808,1808,1952,1816,1816,1816,1960
.long 1824,1824,1824,1968,1832,1832,1832,1976,1840,1840,1840,1984,1848,1848,1848,1992
.long 2016,2016,2016,2160,2024,2024,2024,2168,2032,2032,2032,2176,2040,2040,2040,2184
.long 2048,2048,2048,2192,2056,2056,2056,2200,2064,2064,2064,2208,2072,2072,2072,2216
.long 2080,2080,2080,2224,2088,2088,2088,2232,2096,2096,2096,2240,2104,2104,2104,2248
.long 2112,2112,2112,2256,2120,2120,2120,2264,2128,2128,2128,2272,2136,2136,2136,2280
.long 576,720,864,1008,584,728,872,1016,592,736,880,1024,600,744,888,1032
.long 608,752,896,1040,616,760,904,1048,624,768,912,1056,632,776,920,1064
.long 640,784,928,1072,648,792,936,1080,656,800,944,1088,664,808,952,1096
.long 672,816,960,1104,680,824,968,1112,688,832,976,1120,696,840,984,1128
.long 1440,1440,1584,1156,1448,1448,1592,1164,1456,1456,1600,1172,1464,1464,1608,1180
.long 1472,1472,1616,1188,1480,1480,1624,1196,1488,1488,1632,1204,1496,1496,1640,1212
.long 1504,1504,1648,1220,1512,1512,1656,1228,1520,1520,1664,1236,1528,1528,1672,1244
.long 1536,1536,1680,1252,1544,1544,1688,1260,1552,1552,1696,1268,1560,1560,1704,1276
.long 1872,1872,1732,1732,1880,1880,1740,1740,1888,1888,1748,1748,1896,1896,1756,1756
.long 1904,1904,1764,1764,1912,1912,1772,1772,1920,1920,1780,1780,1928,1928,1788,1788
.long 1936,1936,1796,1796,1944,1944,1804,1804,1952,1952,1812,1812,1960,1960,1820,1820
.long 1968,1968,1828,1828,1976,1976,1836,1836,1984,1984,1844,1844,1992,1992,1852,1852
.long 2160,2160,2020,2020,2168,2168,2028,2028,2176,2176,2036,2036,2184,2184,2044,2044
.long 2192,2192,2052,2052,2200,2200,2060,2060,2208,2208,2068,2068,2216,2216,2076,2076
.long 2224,2224,2084,2084,2232,2232,2092,2092,2240,2240,2100,2100,2248,2248,2108,2108
.long 2256,2256,2116,2116,2264,2264,2124,2124,2272,2272,2132,2132,2280,2280,2140,2140
.long 4,148,292,436,12,156,300,444,20,164,308,452,28,172,316,460
.long 36,180,324,468,44,188,332,476,52,196,340,484,60,204,348,492
.long 68,212,356,500,76,220,364,508,84,228,372,516,92,236,380,524
.long 100,244,388,532,108,252,396,540,116,260,404,548,124,268,412,556
.long 1156,1156,1300,1444,1164,1164,1308,1452,1172,1172,1316,1460,1180,1180,1324,1468
.long 1188,1188,1332,1476,1196,1196,1340,1484,1204,1204,1348,1492,1212,1212,1356,1500
.long 1220,1220,1364,1508,1228,1228,1372,1516,1236,1236,1380,1524,1244,1244,1388,1532
.long 1252,1252,1396,1540,1260,1260,1404,1548,1268,1268,1412,1556,1276,1276,1420,1564
.long 1732,1732,1732,1876,1740,1740,1740,1884,1748,1748,1748,1892,1756,1756,1756,1900
.long 1764,1764,1764,1908,1772,1772,1772,1916,1780,1780,1780,1924,1788,1788,1788,1932
.long 1796,1796,1796,1940,1804,1804,1804,1948,1812,1812,1812,1956,1820,1820,1820,1964
.long 1828,1828,1828,1972,1836,1836,1836,1980,1844,1844,1844,1988,1852,1852,1852,1996
.long 2020,2020,2020,2164,2028,2028,2028,2172,2036,2036,2036,2180,2044,2044,2044,2188
.long 2052,2052,2052,2196,2060,2060,2060,2204,2068,2068,2068,2212,2076,2076,2076,2220
.long 2084,2084,2084,2228,2092,2092,2092,2236,2100,2100,2100,2244,2108,2108,2108,2252
.long 2116,2116,2116,2260,2124,2124,2124,2268,2132,2132,2132,2276,2140,2140,2140,2284
.long 580,724,868,1012,588,732,876,1020,596,740,884,1028,604,748,892,1036
.long 612,756,900,1044,620,764,908,1052,628,772,916,1060,636,780,924,1068
.long 644,788,932,1076,652,796,940,1084,660,804,948,1092,668,812,956,1100
.long 676,820,964,1108,684,828,972,1116,692,836,980,1124,700,844,988,1132
.long 1444,1444,1588,1160,1452,1452,1596,1168,1460,1460,1604,1176,1468,1468,1612,1184
.long 1476,1476,1620,1192,1484,1484,1628,1200,1492,1492,1636,1208,1500,1500,1644,1216
.long 1508,1508,1652,1224,1516,1516,1660,1232,1524,1524,1668,1240,1532,1532,1676,1248
.long 1540,1540,1684,1256,1548,1548,1692,1264,1556,1556,1700,1272,1564,1564,1708,1728
.long 1876,1876,1736,1736,1884,1884,1744,1744,1892,1892,1752,1752,1900,1900,1760,1760
.long 1908,1908,1768,1768,1916,1916,1776,1776,1924,1924,1784,1784,1932,1932,1792,1792
.long 1940,1940,1800,1800,1948,1948,1808,1808,1956,1956,1816,1816,1964,1964,1824,1824
.long 1972,1972,1832,1832,1980,1980,1840,1840,1988,1988,1848,1848,1996,1996,2016,2016
.long 2164,2164,2024,2024,2172,2172,2032,2032,2180,2180,2040,2040,2188,2188,2048,2048
.long 2196,2196,2056,2056,2204,2204,2064,2064,2212,2212,2072,2072,2220,2220,2080,2080
.long 2228,2228,2088,2088,2236,2236,2096,2096,2244,2244,2104,2104,2252,2252,2112,2112
.long 2260,2260,2120,2120,2268,2268,2128,2128,2276,2276,2136,2136,2284,2284,2304,2304
.long 2304,2304,2304,2304,2312,2312,2312,2312,2320,2320,2320,2320,2328,2328,2328,2328
.long 2336,2336,2336,2336,2344,2344,2344,2344,2352,2352,2352,2352,2360,2360,2360,2360
.long 2368,2368,2368,2368,2376,2376,2376,2376,2384,2384,2384,2384,2392,2392,2392,2392
.long 2400,2400,2400,2400,2408,2408,2408,2408,2416,2416,2416,2416,2424,2424,2424,2424
.long 2448,2448,2448,2448,2456,2456,2456,2456,2464,2464,2464,2464,2472,2472,2472,2472
.long 2480,2480,2480,2480,2488,2488,2488,2488,2496,2496,2496,2496,2504,2504,2504,2504
.long 2512,2512,2512,2512,2520,2520,2520,2520,2528,2528,2528,2528,2536,2536,2536,2536
.long 2544,2544,2544,2544,2552,2552,2552,2552,2560,2560,2560,2560,2568,2568,2568,2568
.long 2592,2592,2592,2592,2600,2600,2600,2600,2608,2608,2608,2608,2616,2616,2616,2616
.long 2624,2624,2624,2624,2632,2632,2632,2632,2640,2640,2640,2640,2648,2648,2648,2648
.long 2656,2656,2656,2656,2664,2664,2664,2664,2672,2672,2672,2672,2680,2680,2680,2680
.long 2688,2688,2688,2688,2696,2696,2696,2696,2704,2704,2704,2704,2712,2712,2712,2712
.long 2736,2736,2736,2736,2744,2744,2744,2744,2752,2752,2752,2752,2760,2760,2760,2760
.long 2768,2768,2768,2768,2776,2776,2776,2776,2784,2784,2784,2784,2792,2792,2792,2792
.long 2800,2800,2800,2800,2808,2808,2808,2808,2816,2816,2816,2816,2824,2824,2824,2824
.long 2832,2832,2832,2832,2840,2840,2840,2840,2848,2848,2848,2848,2856,2856,2856,2856
.long 2304,2308,2308,2308,2312,2316,2316,2316,2320,2324,2324,2324,2328,2332,2332,2332
.long 2336,2340,2340,2340,2344,2348,2348,2348,2352,2356,2356,2356,2360,2364,2364,2364
.long 2368,2372,2372,2372,2376,2380,2380,2380,2384,2388,2388,2388,2392,2396,2396,2396
.long 2400,2404,2404,2404,2408,2412,2412,2412,2416,2420,2420,2420,2424,2428,2428,2428
.long 2448,2452,2452,2452,2456,2460,2460,2460,2464,2468,2468,2468,2472,2476,2476,2476
.long 2480,2484,2484,2484,2488,2492,2492,2492,2496,2500,2500,2500,2504,2508,2508,2508
.long 2512,2516,2516,2516,2520,2524,2524,2524,2528,2532,2532,2532,2536,2540,2540,2540
.long 2544,2548,2548,2548,2552,2556,2556,2556,2560,2564,2564,2564,2568,2572,2572,2572
.long 2592,2596,2596,2596,2600,2604,2604,2604,2608,2612,2612,2612,2616,2620,2620,2620
.long 2624,2628,2628,2628,2632,2636,2636,2636,2640,2644,2644,2644,2648,2652,2652,2652
.long 2656,2660,2660,2660,2664,2668,2668,2668,2672,2676,2676,2676,2680,2684,2684,2684
.long 2688,2692,2692,2692,2696,2700,2700,2700,2704,2708,2708,2708,2712,2716,2716,2716
.long 2736,2740,2740,2740,2744,2748,2748,2748,2752,2756,2756,2756,2760,2764,2764,2764
.long 2768,2772,2772,2772,2776,2780,2780,2780,2784,2788,2788,2788,2792,2796,2796,2796
.long 2800,2804,2804,2804,2808,2812,2812,2812,2816,2820,2820,2820,2824,2828,2828,2828
.long 2832,2836,2836,2836,2840,2844,2844,2844,2848,2852,2852,2852,2856,2860,2860,2860
.long 2308,2308,2308,2308,2316,2316,2316,2316,2324,2324,2324,2324,2332,2332,2332,2332
.long 2340,2340,2340,2340,2348,2348,2348,2348,2356,2356,2356,2356,2364,2364,2364,2364
.long 2372,2372,2372,2372,2380,2380,2380,2380,2388,2388,2388,2388,2396,2396,2396,2396
.long 2404,2404,2404,2404,2412,2412,2412,2412,2420,2420,2420,2420,2428,2428,2428,2428
.long 2452,2452,2452,2452,2460,2460,2460,2460,2468,2468,2468,2468,2476,2476,2476,2476
.long 2484,2484,2484,2484,2492,2492,2492,2492,2500,2500,2500,2500,2508,2508,2508,2508
.long 2516,2516,2516,2516,2524,2524,2524,2524,2532,2532,2532,2532,2540,2540,2540,2540
.long 2548,2548,2548,2548,2556,2556,2556,2556,2564,2564,2564,2564,2572,2572,2572,2572
.long 2596,2596,2596,2596,2604,2604,2604,2604,2612,2612,2612,2612,2620,2620,2620,2620
.long 2628,2628,2628,2628,2636,2636,2636,2636,2644,2644,2644,2644,2652,2652,2652,2652
.long 2660,2660,2660,2660,2668,2668,2668,2668,2676,2676,2676,2676,2684,2684,2684,2684
.long 2692,2692,2692,2692,2700,2700,2700,2700,2708,2708,2708,2708,2716,2716,2716,2716
.long 2740,2740,2740,2740,2748,2748,2748,2748,2756,2756,2756,2756,2764,2764,2764,2764
.long 2772,2772,2772,2772,2780,2780,2780,2780,2788,2788,2788,2788,2796,2796,2796,2796
.long 2804,2804,2804,2804,2812,2812,2812,2812,2820,2820,2820,2820,2828,2828,2828,2828
.long 2836,2836,2836,2836,2844,2844,2844,2844,2852,2852,2852,2852,2860,2860,2860,2860
.long 2312,2312,2312,2312,2320,2320,2320,2320,2328,2328,2328,2328,2336,2336,2336,2336
.long 2344,2344,2344,2344,2352,2352,2352,2352,2360,2360,2360,2360,2368,2368,2368,2368
.long 2376,2376,2376,2376,2384,2384,2384,2384,2392,2392,2392,2392,2400,2400,2400,2400
.long 2408,2408,2408,2408,2416,2416,2416,2416,2424,2424,2424,2424,2448,2448,2448,2448
.long 2456,2456,2456,2456,2464,2464,2464,2464,2472,2472,2472,2472,2480,2480,2480,2480
.long 2488,2488,2488,2488,2496,2496,2496,2496,2504,2504,2504,2504,2512,2512,2512,2512
.long 2520,2520,2520,2520,2528,2528,2528,2528,2536,2536,2536,2536,2544,2544,2544,2544
.long 2552,2552,2552,2552,2560,2560,2560,2560,2568,2568,2568,2568,2592,2592,2592,2592
.long 2600,2600,2600,2600,2608,2608,2608,2608,2616,2616,2616,2616,2624,2624,2624,2624
.long 2632,2632,2632,2632,2640,2640,2640,2640,2648,2648,2648,2648,2656,2656,2656,2656
.long 2664,2664,2664,2664,2672,2672,2672,2672,2680,2680,2680,2680,2688,2688,2688,2688
.long 2696,2696,2696,2696,2704,2704,2704,2704,2712,2712,2712,2712,2736,2736,2736,2736
.long 2744,2744,2744,2744,2752,2752,2752,2752,2760,2760,2760,2760,2768,2768,2768,2768
.long 2776,2776,2776,2776,2784,2784,2784,2784,2792,2792,2792,2792,2800,2800,2800,2800
.long 2808,2808,2808,2808,2816,2816,2816,2816,2824,2824,2824,2824,2832,2832,2832,2832
.long 2840,2840,2840,2840,2848,2848,2848,2848,2856,2856,2856,2856,2880,2880,2880,2880
.section .rodata,"a"
.p2align 6
.amdhsa_kernel concat_heads__ssm_conv_s4d__grouped_kv_mqa__prompt_kernel
  .amdhsa_next_free_vgpr 256
  .amdhsa_next_free_sgpr 102
  .amdhsa_accum_offset 256
  .amdhsa_group_segment_fixed_size 0
  .amdhsa_kernarg_size 120
  .amdhsa_user_sgpr_count 2
  .amdhsa_user_sgpr_kernarg_segment_ptr 1
  .amdhsa_system_sgpr_workgroup_id_x 1
.end_amdhsa_kernel
```
